```python
import torch

def _softmax(x, axis=-1):
    return torch.softmax(x, dim=axis)
def _gelu(x):
    return torch.nn.functional.gelu(x, approximate="tanh")
def _silu(x):
    return torch.nn.functional.silu(x)
def _sigmoid(x):
    return torch.sigmoid(x)
def _layernorm(x, axis=-1, eps=1e-5):
    m = x.mean(dim=axis, keepdim=True)
    v = x.var(dim=axis, keepdim=True, unbiased=False)
    return (x - m) / torch.sqrt(v + eps)
def _scatter_add(tgt, idx, src, axis=0):
    return tgt.clone().index_add_(axis, idx, src)
def _segment_sum(src, seg, n):
    out = torch.zeros((n,) + src.shape[1:], dtype=src.dtype)
    return out.index_add_(0, seg, src)
def _pad(x, pw):
    flat = tuple(v for pair in reversed(pw) for v in pair)
    return torch.nn.functional.pad(x, flat)

kernel_name = 'gated_mix__ssm_conv_s5__dense_activation_silu__prompt'

def setup_inputs():

    _w = (lambda a: (lambda t: t.to(torch.bfloat16) if t.is_floating_point() else t)(torch.as_tensor(a)))
    def _A_setup():
        B, S, D = 1, 2048, 512
        P = D
        Lambda_re = -0.5 * (lambda _x: torch.exp(torch.as_tensor(_x)))((lambda *s: torch.randn(*s, dtype=torch.bfloat16) * 0.2)(P))
        Lambda_im = (lambda *s: torch.randn(*s, dtype=torch.bfloat16) * 0.4)(P) * 1.0
        B_re = (lambda *s: torch.randn(*s, dtype=torch.bfloat16) * 0.2)(P, D) * (D ** -0.5)
        B_im = (lambda *s: torch.randn(*s, dtype=torch.bfloat16) * 0.2)(P, D) * (D ** -0.5)
        C_re = (lambda *s: torch.randn(*s, dtype=torch.bfloat16) * 0.2)(D, P) * (P ** -0.5)
        C_im = (lambda *s: torch.randn(*s, dtype=torch.bfloat16) * 0.2)(D, P) * (P ** -0.5)
        log_dt = (lambda *s: torch.randn(*s, dtype=torch.bfloat16) * 0.2)(P) * 0.3 - 2.0
        Dskip = (lambda *s: torch.randn(*s, dtype=torch.bfloat16) * 0.05)(D)
        return {
            "x": _w((lambda *s: torch.randn(*s, dtype=torch.bfloat16) * 0.05)(B, S, D)),
            "Lambda_re": _w(Lambda_re),
            "Lambda_im": _w(Lambda_im),
            "B_re": _w(B_re),
            "B_im": _w(B_im),
            "C_re": _w(C_re),
            "C_im": _w(C_im),
            "log_dt": _w(log_dt),
            "Dskip": _w(Dskip),
        }
    _A_in = _A_setup()

    def _B_setup():
        B, S, D, F = 1, 2048, 512, 1792
        return {
            "x": _w((lambda *s: torch.randn(*s, dtype=torch.bfloat16) * 0.05)(B, S, D)),
            "w1": _w((lambda *s: torch.randn(*s, dtype=torch.bfloat16) * 3.2)(D, F) * (D ** -0.5)),
            "w2": _w((lambda *s: torch.randn(*s, dtype=torch.bfloat16) * 0.1)(F, D) * (F ** -0.5)),
        }
    _B_in = _B_setup()

    return {
        "A_x": _A_in["x"],
        "A_Lambda_re": _A_in["Lambda_re"],
        "A_Lambda_im": _A_in["Lambda_im"],
        "A_B_re": _A_in["B_re"],
        "A_B_im": _A_in["B_im"],
        "A_C_re": _A_in["C_re"],
        "A_C_im": _A_in["C_im"],
        "A_log_dt": _A_in["log_dt"],
        "A_Dskip": _A_in["Dskip"],
        "B_x": _B_in["x"],
        "B_w1": _B_in["w1"],
        "B_w2": _B_in["w2"],
        "gate_w": _w((lambda *s: torch.randn(*s, dtype=torch.bfloat16) * 0.05)(512) * 16.0),
    }

def reference(A_x, A_Lambda_re, A_Lambda_im, A_B_re, A_B_im, A_C_re, A_C_im, A_log_dt, A_Dskip, B_x, B_w1, B_w2, gate_w):
    def _A_ref(x, Lambda_re, Lambda_im, B_re, B_im, C_re, C_im, log_dt, Dskip):
        Bsz, L, H = x.shape
        Lam = Lambda_re + 1j * Lambda_im
        Bmat = B_re + 1j * B_im
        Cmat = C_re + 1j * C_im
        dt = torch.exp(log_dt)
        Lam_bar = torch.exp(dt * Lam)
        B_bar = ((Lam_bar - 1.0) / Lam)[:, None] * Bmat
        Bu = torch.einsum("bld,pd->blp", x + 0j, B_bar)
        h = torch.zeros_like(Bu[:, 0, :])
        hs = []
        for t in range(L):
            h = Lam_bar[None, :] * h + Bu[:, t, :]
            hs.append(h)
        hseq = torch.stack(hs, 1)
        y = 2.0 * torch.einsum("blp,dp->bld", hseq, Cmat).real + x * Dskip[None, None, :]
        return y

    def _B_ref(x, w1, w2):
        h = torch.einsum("bsd,df->bsf", x, w1)
        h = _silu(h)
        out = torch.einsum("bsf,fd->bsd", h, w2)
        return out

    x = A_x
    g = _sigmoid((x * gate_w).sum(-1, keepdims=True))
    a = _A_ref(x, A_Lambda_re, A_Lambda_im, A_B_re, A_B_im, A_C_re, A_C_im, A_log_dt, A_Dskip)
    b = _B_ref(x, B_w1, B_w2)
    return g * a + (1 - g) * b
```

```asm
; @launch grid=(256,1,1) block=(512,1,1) lds=163840
.amdgcn_target "amdgcn-amd-amdhsa--gfx950"
.text
.globl gated_mix__ssm_conv_s5__dense_activation_silu__prompt_kernel
.p2align 8
.type gated_mix__ssm_conv_s5__dense_activation_silu__prompt_kernel,@function
gated_mix__ssm_conv_s5__dense_activation_silu__prompt_kernel:
    s_cmp_ge_u32 s2, 256
    s_cbranch_scc1 K1_END
    s_load_dwordx16 s[16:31], s[0:1], 0
    s_load_dwordx4 s[32:35], s[0:1], 80
    s_load_dwordx2 s[36:37], s[0:1], 96
    s_load_dwordx4 s[40:43], s[0:1], 112
    v_lshrrev_b32 v1, 6, v0
    v_and_b32 v0, 63, v0
    v_readfirstlane_b32 s3, v1
    s_and_b32 s9, s2, 7
    s_lshr_b32 s76, s2, 3
    s_and_b32 s5, s9, 1
    s_lshl_b32 s5, s5, 3
    s_lshr_b32 s77, s76, 2
    s_add_u32 s5, s5, s77
    s_lshr_b32 s9, s9, 1
    s_and_b32 s76, s76, 3
    s_lshl_b32 s6, s9, 2
    s_add_u32 s6, s6, s76
    s_and_b32 s4, s3, 3
    s_mul_i32 s77, s9, 3
    s_add_u32 s77, s77, s76
    s_lshl_b32 s77, s77, 8
    s_lshl_b32 s78, s9, 7
    s_add_u32 s78, s78, 3072
    s_cmp_eq_u32 s76, 3
    s_cselect_b32 s7, s78, s77
    s_cselect_b32 s8, 1, 0
    s_lshl_b32 s13, s5, 2
    s_add_u32 s13, s13, s9
    s_cmp_lt_u32 s3, 4
    s_cbranch_scc1 K1_AWAVE
    s_cmp_lg_u32 s8, 0
    s_cbranch_scc1 KB_EQ
    v_lshrrev_b32 v12, 4, v0
    v_and_b32 v13, 15, v0
    v_xor_b32 v13, v13, v12
    v_lshlrev_b32 v13, 4, v13
    v_lshl_add_u32 v5, v12, 10, v13
    v_and_b32 v15, 1, v12
    v_lshrrev_b32 v12, 1, v12
    v_lshl_add_u32 v12, v15, 3, v12
    v_lshl_add_u32 v1, v12, 10, v13
    v_xor_b32 v2, 64, v1
    v_add_u32 v2, 15360, v2
    v_xor_b32 v3, 128, v1
    v_xor_b32 v4, 192, v1
    v_add_u32 v4, 15360, v4
    s_lshl_b32 s10, s5, 2
    s_add_u32 s10, s10, s4
    s_lshl_b32 s10, s10, 15
    s_lshl_b32 s79, s4, 13
    s_lshl_b32 s9, s4, 12
    s_waitcnt lgkmcnt(0)
    s_mov_b32 s44, s16
    s_and_b32 s45, s17, 0xffff
    s_mov_b32 s46, 2097152
    s_mov_b32 s47, 0x20000
    s_add_u32 m0, s79, 0
    s_add_u32 s77, s10, 0
    buffer_load_dwordx4 v1, s[44:47], s77 offen offset:0 lds
    buffer_load_dwordx4 v2, s[44:47], s77 offen offset:1024 lds
    buffer_load_dwordx4 v3, s[44:47], s77 offen offset:2048 lds
    buffer_load_dwordx4 v4, s[44:47], s77 offen offset:3072 lds
    s_add_u32 m0, s79, 4096
    s_add_u32 s77, s10, 4096
    buffer_load_dwordx4 v1, s[44:47], s77 offen offset:0 lds
    buffer_load_dwordx4 v2, s[44:47], s77 offen offset:1024 lds
    buffer_load_dwordx4 v3, s[44:47], s77 offen offset:2048 lds
    buffer_load_dwordx4 v4, s[44:47], s77 offen offset:3072 lds
    v_xor_b32 v6, 64, v5
    v_add_u32 v6, 3072, v6
    v_xor_b32 v7, 128, v5
    v_add_u32 v7, 6144, v7
    v_xor_b32 v96, 192, v5
    v_add_u32 v96, 9216, v96
    s_lshl_b32 s11, s6, 1
    s_and_b32 s76, s4, 1
    s_add_u32 s11, s11, s76
    s_lshl_b32 s11, s11, 14
    s_cmp_lt_u32 s4, 2
    s_cselect_b32 s48, s22, s24
    s_cselect_b32 s49, s23, s25
    s_and_b32 s49, s49, 0xffff
    s_mov_b32 s50, 524288
    s_mov_b32 s51, 0x20000
    s_add_u32 m0, s9, 32768
    s_add_u32 s77, s11, 0
    buffer_load_dwordx4 v5, s[48:51], s77 offen offset:0 lds
    buffer_load_dwordx4 v6, s[48:51], s77 offen offset:1024 lds
    buffer_load_dwordx4 v7, s[48:51], s77 offen offset:2048 lds
    buffer_load_dwordx4 v96, s[48:51], s77 offen offset:3072 lds
    s_add_u32 m0, s79, 49152
    s_add_u32 s77, s10, 256
    buffer_load_dwordx4 v1, s[44:47], s77 offen offset:0 lds
    buffer_load_dwordx4 v2, s[44:47], s77 offen offset:1024 lds
    buffer_load_dwordx4 v3, s[44:47], s77 offen offset:2048 lds
    buffer_load_dwordx4 v4, s[44:47], s77 offen offset:3072 lds
    s_add_u32 m0, s79, 53248
    s_add_u32 s77, s10, 4352
    buffer_load_dwordx4 v1, s[44:47], s77 offen offset:0 lds
    buffer_load_dwordx4 v2, s[44:47], s77 offen offset:1024 lds
    buffer_load_dwordx4 v3, s[44:47], s77 offen offset:2048 lds
    buffer_load_dwordx4 v4, s[44:47], s77 offen offset:3072 lds
    s_add_u32 m0, s9, 81920
    s_add_u32 s77, s11, 256
    buffer_load_dwordx4 v5, s[48:51], s77 offen offset:0 lds
    buffer_load_dwordx4 v6, s[48:51], s77 offen offset:1024 lds
    buffer_load_dwordx4 v7, s[48:51], s77 offen offset:2048 lds
    buffer_load_dwordx4 v96, s[48:51], s77 offen offset:3072 lds
    v_lshrrev_b32 v12, 3, v0
    v_mul_u32_u24 v97, 3584, v12
    v_lshlrev_b32 v98, 10, v12
    v_bfe_u32 v12, v0, 4, 1
    v_lshlrev_b32 v12, 2, v12
    v_and_b32 v13, 7, v0
    v_xor_b32 v13, v13, v12
    v_lshl_add_u32 v97, v13, 4, v97
    v_lshl_add_u32 v98, v13, 4, v98
    s_mul_i32 s12, s4, 114688
    s_add_u32 s12, s12, s7
    s_mov_b32 s52, s32
    s_and_b32 s53, s33, 0xffff
    s_mov_b32 s54, 1835008
    s_mov_b32 s55, 0x20000
    v_and_b32 v12, 31, v0
    v_lshrrev_b32 v13, 5, v0
    v_and_b32 v15, 15, v0
    v_xor_b32 v13, v13, v15
    v_lshlrev_b32 v13, 4, v13
    v_lshl_add_u32 v9, v12, 8, v13
    s_lshl_b32 s76, s4, 13
    v_add_u32 v8, s76, v9
    v_lshrrev_b32 v12, 5, v0
    v_lshlrev_b32 v12, 3, v12
    v_bfe_u32 v13, v0, 2, 2
    v_add_u32 v12, v12, v13
    v_lshlrev_b32 v12, 7, v12
    v_bfe_u32 v13, v0, 3, 1
    v_lshl_add_u32 v12, v13, 6, v12
    v_bfe_u32 v13, v0, 4, 1
    v_lshl_add_u32 v12, v13, 5, v12
    v_and_b32 v13, 3, v0
    v_lshl_add_u32 v10, v13, 3, v12
    v_xor_b32 v11, 64, v10
    v_lshlrev_b32 v14, 4, v0
    s_mov_b32 s56, s42
    s_and_b32 s57, s43, 0xffff
    s_mov_b32 s58, 14655488
    s_mov_b32 s59, 0x20000
    s_lshl_b32 s80, s5, 2
    s_add_u32 s80, s80, s4
    s_mul_i32 s80, s80, 180224
    s_lshl_b32 s76, s5, 7
    s_lshl_b32 s77, s6, 3
    s_add_u32 s76, s76, s77
    s_lshl_b32 s77, s4, 1
    s_add_u32 s21, s76, s77
    s_lshl_b32 s76, s21, 10
    buffer_load_dwordx4 v[48:51], v14, s[44:47], s76 offen
    buffer_load_dwordx4 v[52:55], v14, s[44:47], s76 offen offset:1024
    s_mov_b32 s64, s36
    s_and_b32 s65, s37, 0xffff
    s_mov_b32 s66, 1024
    s_mov_b32 s67, 0x20000
    buffer_load_dwordx4 v[56:59], v14, s[64:67], 0 offen
    s_waitcnt vmcnt(15) lgkmcnt(0)
    s_barrier
    v_add_u32 v15, 0, v8
    ds_read_b128 a[0:3], v15
    v_xor_b32 v12, 32, v15
    ds_read_b128 a[4:7], v12
    v_xor_b32 v12, 64, v15
    ds_read_b128 a[8:11], v12
    v_xor_b32 v12, 96, v15
    ds_read_b128 a[12:15], v12
    v_xor_b32 v12, 128, v15
    ds_read_b128 a[16:19], v12
    v_xor_b32 v12, 160, v15
    ds_read_b128 a[20:23], v12
    v_xor_b32 v12, 192, v15
    ds_read_b128 a[24:27], v12
    v_xor_b32 v12, 224, v15
    ds_read_b128 a[28:31], v12
    s_add_u32 m0, s79, 98304
    s_add_u32 s77, s10, 512
    buffer_load_dwordx4 v1, s[44:47], s77 offen offset:0 lds
    buffer_load_dwordx4 v2, s[44:47], s77 offen offset:1024 lds
    buffer_load_dwordx4 v3, s[44:47], s77 offen offset:2048 lds
    buffer_load_dwordx4 v4, s[44:47], s77 offen offset:3072 lds
    s_add_u32 m0, s79, 102400
    s_add_u32 s77, s10, 4608
    buffer_load_dwordx4 v1, s[44:47], s77 offen offset:0 lds
    buffer_load_dwordx4 v2, s[44:47], s77 offen offset:1024 lds
    buffer_load_dwordx4 v3, s[44:47], s77 offen offset:2048 lds
    buffer_load_dwordx4 v4, s[44:47], s77 offen offset:3072 lds
    s_add_u32 m0, s9, 131072
    s_add_u32 s77, s11, 512
    buffer_load_dwordx4 v5, s[48:51], s77 offen offset:0 lds
    buffer_load_dwordx4 v6, s[48:51], s77 offen offset:1024 lds
    buffer_load_dwordx4 v7, s[48:51], s77 offen offset:2048 lds
    buffer_load_dwordx4 v96, s[48:51], s77 offen offset:3072 lds
    s_mov_b32 s64, s34
    s_and_b32 s65, s35, 0xffff
    s_mov_b32 s66, 1835008
    s_mov_b32 s67, 0x20000
    s_lshr_b32 s76, s13, 5
    s_cmp_eq_u32 s76, 0
    s_cselect_b32 s68, s26, s28
    s_cselect_b32 s69, s27, s29
    s_and_b32 s69, s69, 0xffff
    s_mov_b32 s70, 524288
    s_mov_b32 s71, 0x20000
    s_mov_b32 s16, 0xbfb8aa3b
    s_mov_b32 s17, 0xbfb8aa3b
    s_mov_b32 s18, 1.0
    s_mov_b32 s19, 1.0
    s_mov_b32 s20, 0xffff0000
    s_waitcnt vmcnt(15) lgkmcnt(0)
    s_barrier
    v_add_u32 v15, 49152, v8
    ds_read_b128 a[32:35], v15
    v_xor_b32 v12, 32, v15
    ds_read_b128 a[36:39], v12
    v_xor_b32 v12, 64, v15
    ds_read_b128 a[40:43], v12
    v_xor_b32 v12, 96, v15
    ds_read_b128 a[44:47], v12
    v_xor_b32 v12, 128, v15
    ds_read_b128 a[48:51], v12
    v_xor_b32 v12, 160, v15
    ds_read_b128 a[52:55], v12
    v_xor_b32 v12, 192, v15
    ds_read_b128 a[56:59], v12
    v_xor_b32 v12, 224, v15
    ds_read_b128 a[60:63], v12
    s_add_u32 m0, s79, 0
    s_add_u32 s77, s10, 768
    buffer_load_dwordx4 v1, s[44:47], s77 offen offset:0 lds
    buffer_load_dwordx4 v2, s[44:47], s77 offen offset:1024 lds
    buffer_load_dwordx4 v3, s[44:47], s77 offen offset:2048 lds
    buffer_load_dwordx4 v4, s[44:47], s77 offen offset:3072 lds
    s_add_u32 m0, s79, 4096
    s_add_u32 s77, s10, 4864
    buffer_load_dwordx4 v1, s[44:47], s77 offen offset:0 lds
    buffer_load_dwordx4 v2, s[44:47], s77 offen offset:1024 lds
    buffer_load_dwordx4 v3, s[44:47], s77 offen offset:2048 lds
    buffer_load_dwordx4 v4, s[44:47], s77 offen offset:3072 lds
    s_add_u32 m0, s9, 32768
    s_add_u32 s77, s11, 768
    buffer_load_dwordx4 v5, s[48:51], s77 offen offset:0 lds
    buffer_load_dwordx4 v6, s[48:51], s77 offen offset:1024 lds
    buffer_load_dwordx4 v7, s[48:51], s77 offen offset:2048 lds
    buffer_load_dwordx4 v96, s[48:51], s77 offen offset:3072 lds
    s_lshr_b32 s77, s13, 3
    s_mul_i32 s14, s77, 229376
    s_and_b32 s78, s13, 7
    s_lshl_b32 s78, s78, 7
    s_add_u32 s14, s14, s78
    s_lshl_b32 s78, s4, 16
    s_add_u32 s14, s14, s78
    s_lshr_b32 s77, s13, 1
    s_and_b32 s77, s77, 15
    s_lshl_b32 s15, s77, 15
    s_and_b32 s78, s13, 1
    s_lshl_b32 s78, s78, 9
    s_add_u32 s15, s15, s78
    s_lshl_b32 s78, s4, 13
    s_add_u32 s15, s15, s78
    v_lshrrev_b32 v13, 5, v0
    v_and_b32 v12, 31, v0
    v_xor_b32 v12, v12, v13
    s_and_b32 s78, s4, 1
    s_lshl_b32 s78, s78, 3
    v_xor_b32 v12, s78, v12
    v_lshlrev_b32 v12, 4, v12
    v_lshl_add_u32 v99, v13, 10, v12
    s_waitcnt vmcnt(12) lgkmcnt(0)
    s_barrier
    v_add_u32 v15, 98304, v8
    ds_read_b128 a[64:67], v15
    v_xor_b32 v12, 32, v15
    ds_read_b128 a[68:71], v12
    v_xor_b32 v12, 64, v15
    ds_read_b128 a[72:75], v12
    v_xor_b32 v12, 96, v15
    ds_read_b128 a[76:79], v12
    v_xor_b32 v12, 128, v15
    ds_read_b128 a[80:83], v12
    v_xor_b32 v12, 160, v15
    ds_read_b128 a[84:87], v12
    v_xor_b32 v12, 192, v15
    ds_read_b128 a[88:91], v12
    v_xor_b32 v12, 224, v15
    ds_read_b128 a[92:95], v12
    s_add_u32 m0, s9, 147456
    s_add_u32 s77, s12, 0
    buffer_load_dwordx4 v97, s[52:55], s77 offen offset:0 lds
    v_mov_b32 v120, 0
    v_lshlrev_b32 v116, 16, v48
    v_and_b32 v117, 0xffff0000, v48
    v_lshlrev_b32 v118, 16, v56
    v_and_b32 v119, 0xffff0000, v56
    v_mul_f32 v116, v116, v118
    v_mul_f32 v117, v117, v119
    v_cvt_pk_bf16_f32 v116, v116, v117
    s_add_u32 s77, s77, 27648
    buffer_load_dwordx4 v97, s[52:55], s77 offen offset:1024 lds
    v_lshlrev_b32 v117, 16, v116
    v_and_b32 v116, 0xffff0000, v116
    v_add_f32 v120, v120, v117
    v_add_f32 v120, v120, v116
    v_lshlrev_b32 v116, 16, v49
    v_and_b32 v117, 0xffff0000, v49
    v_lshlrev_b32 v118, 16, v57
    v_and_b32 v119, 0xffff0000, v57
    s_add_u32 s77, s77, 27648
    buffer_load_dwordx4 v97, s[52:55], s77 offen offset:2048 lds
    v_mul_f32 v116, v116, v118
    v_mul_f32 v117, v117, v119
    v_cvt_pk_bf16_f32 v116, v116, v117
    v_lshlrev_b32 v117, 16, v116
    v_and_b32 v116, 0xffff0000, v116
    v_add_f32 v120, v120, v117
    v_add_f32 v120, v120, v116
    v_lshlrev_b32 v116, 16, v50
    s_add_u32 s77, s77, 27648
    buffer_load_dwordx4 v97, s[52:55], s77 offen offset:3072 lds
    v_and_b32 v117, 0xffff0000, v50
    v_lshlrev_b32 v118, 16, v58
    v_and_b32 v119, 0xffff0000, v58
    v_mul_f32 v116, v116, v118
    v_mul_f32 v117, v117, v119
    v_cvt_pk_bf16_f32 v116, v116, v117
    v_lshlrev_b32 v117, 16, v116
    v_and_b32 v116, 0xffff0000, v116
    s_add_u32 m0, s9, 49152
    s_add_u32 s77, s12, 458752
    buffer_load_dwordx4 v97, s[52:55], s77 offen offset:0 lds
    v_add_f32 v120, v120, v117
    v_add_f32 v120, v120, v116
    v_lshlrev_b32 v116, 16, v51
    v_and_b32 v117, 0xffff0000, v51
    v_lshlrev_b32 v118, 16, v59
    v_and_b32 v119, 0xffff0000, v59
    v_mul_f32 v116, v116, v118
    v_mul_f32 v117, v117, v119
    s_add_u32 s77, s77, 27648
    buffer_load_dwordx4 v97, s[52:55], s77 offen offset:1024 lds
    v_cvt_pk_bf16_f32 v116, v116, v117
    v_lshlrev_b32 v117, 16, v116
    v_and_b32 v116, 0xffff0000, v116
    v_add_f32 v120, v120, v117
    v_add_f32 v120, v120, v116
    v_mov_b32 v121, 0
    v_lshlrev_b32 v116, 16, v52
    s_add_u32 s77, s77, 27648
    buffer_load_dwordx4 v97, s[52:55], s77 offen offset:2048 lds
    v_and_b32 v117, 0xffff0000, v52
    v_lshlrev_b32 v118, 16, v56
    v_and_b32 v119, 0xffff0000, v56
    v_mul_f32 v116, v116, v118
    v_mul_f32 v117, v117, v119
    v_cvt_pk_bf16_f32 v116, v116, v117
    v_lshlrev_b32 v117, 16, v116
    v_and_b32 v116, 0xffff0000, v116
    s_add_u32 s77, s77, 27648
    buffer_load_dwordx4 v97, s[52:55], s77 offen offset:3072 lds
    v_add_f32 v121, v121, v117
    v_add_f32 v121, v121, v116
    v_lshlrev_b32 v116, 16, v53
    v_and_b32 v117, 0xffff0000, v53
    v_lshlrev_b32 v118, 16, v57
    v_and_b32 v119, 0xffff0000, v57
    v_mul_f32 v116, v116, v118
    v_mul_f32 v117, v117, v119
    s_add_u32 m0, s9, 65536
    s_add_u32 s77, s12, 917504
    buffer_load_dwordx4 v97, s[52:55], s77 offen offset:0 lds
    v_cvt_pk_bf16_f32 v116, v116, v117
    v_lshlrev_b32 v117, 16, v116
    v_and_b32 v116, 0xffff0000, v116
    v_add_f32 v121, v121, v117
    v_add_f32 v121, v121, v116
    v_lshlrev_b32 v116, 16, v54
    v_and_b32 v117, 0xffff0000, v54
    v_lshlrev_b32 v118, 16, v58
    s_add_u32 s77, s77, 27648
    buffer_load_dwordx4 v97, s[52:55], s77 offen offset:1024 lds
    v_and_b32 v119, 0xffff0000, v58
    v_mul_f32 v116, v116, v118
    v_mul_f32 v117, v117, v119
    v_cvt_pk_bf16_f32 v116, v116, v117
    v_lshlrev_b32 v117, 16, v116
    v_and_b32 v116, 0xffff0000, v116
    v_add_f32 v121, v121, v117
    v_add_f32 v121, v121, v116
    s_add_u32 s77, s77, 27648
    buffer_load_dwordx4 v97, s[52:55], s77 offen offset:2048 lds
    v_lshlrev_b32 v116, 16, v55
    v_and_b32 v117, 0xffff0000, v55
    v_lshlrev_b32 v118, 16, v59
    v_and_b32 v119, 0xffff0000, v59
    v_mul_f32 v116, v116, v118
    v_mul_f32 v117, v117, v119
    v_cvt_pk_bf16_f32 v116, v116, v117
    s_add_u32 s77, s77, 27648
    buffer_load_dwordx4 v97, s[52:55], s77 offen offset:3072 lds
    v_lshlrev_b32 v117, 16, v116
    v_and_b32 v116, 0xffff0000, v116
    v_add_f32 v121, v121, v117
    v_add_f32 v121, v121, v116
    s_nop 0
    v_add_f32_dpp v120, v120, v120 row_shr:1 bound_ctrl:0
    v_add_f32_dpp v121, v121, v121 row_shr:1 bound_ctrl:0
    s_nop 0
    s_add_u32 m0, s9, 81920
    s_add_u32 s77, s12, 1376256
    buffer_load_dwordx4 v97, s[52:55], s77 offen offset:0 lds
    v_add_f32_dpp v120, v120, v120 row_shr:2 bound_ctrl:0
    v_add_f32_dpp v121, v121, v121 row_shr:2 bound_ctrl:0
    s_nop 0
    v_add_f32_dpp v120, v120, v120 row_shr:4 bound_ctrl:0
    v_add_f32_dpp v121, v121, v121 row_shr:4 bound_ctrl:0
    s_nop 0
    v_add_f32_dpp v120, v120, v120 row_shr:8 bound_ctrl:0
    v_add_f32_dpp v121, v121, v121 row_shr:8 bound_ctrl:0
    s_add_u32 s77, s77, 27648
    buffer_load_dwordx4 v97, s[52:55], s77 offen offset:1024 lds
    s_nop 0
    v_add_f32_dpp v120, v120, v120 row_bcast:15 row_mask:0xa
    v_add_f32_dpp v121, v121, v121 row_bcast:15 row_mask:0xa
    s_nop 0
    v_add_f32_dpp v120, v120, v120 row_bcast:31 row_mask:0xc
    v_add_f32_dpp v121, v121, v121 row_bcast:31 row_mask:0xc
    v_cvt_pk_bf16_f32 v120, v120, v120
    v_and_b32 v120, 0xffff0000, v120
    s_add_u32 s77, s77, 27648
    buffer_load_dwordx4 v97, s[52:55], s77 offen offset:2048 lds
    v_mul_f32 v120, 0xbfb8aa3b, v120
    v_cvt_pk_bf16_f32 v121, v121, v121
    v_and_b32 v121, 0xffff0000, v121
    v_mul_f32 v121, 0xbfb8aa3b, v121
    v_exp_f32 v120, v120
    v_exp_f32 v121, v121
    s_nop 0
    v_add_f32 v120, 1.0, v120
    s_add_u32 s77, s77, 27648
    buffer_load_dwordx4 v97, s[52:55], s77 offen offset:3072 lds
    v_add_f32 v121, 1.0, v121
    v_rcp_f32 v120, v120
    v_rcp_f32 v121, v121
    s_nop 0
    v_cvt_pk_bf16_f32 v120, v120, v121
    v_and_b32 v121, 0xffff0000, v120
    v_lshlrev_b32 v120, 16, v120
    s_lshl_b32 s21, s21, 2
    s_add_u32 s21, s21, 14417920
    v_mov_b32 v122, 0
    s_mov_b32 exec_lo, 0
    s_brev_b32 exec_hi, 1
    buffer_store_dwordx2 v[120:121], v122, s[56:59], s21 offen sc1
    s_mov_b64 exec, -1
    s_waitcnt vmcnt(13) lgkmcnt(0)
    s_barrier
    v_add_u32 v15, 0, v8
    ds_read_b128 a[96:99], v15
    v_xor_b32 v12, 32, v15
    ds_read_b128 a[100:103], v12
    v_xor_b32 v12, 64, v15
    ds_read_b128 a[104:107], v12
    v_xor_b32 v12, 96, v15
    ds_read_b128 a[108:111], v12
    v_xor_b32 v12, 128, v15
    ds_read_b128 a[112:115], v12
    v_xor_b32 v12, 160, v15
    ds_read_b128 a[116:119], v12
    v_xor_b32 v12, 192, v15
    ds_read_b128 a[120:123], v12
    v_xor_b32 v12, 224, v15
    ds_read_b128 a[124:127], v12
    s_waitcnt lgkmcnt(0)
    v_add_u32 v12, 147456, v10
    v_add_u32 v13, 147456, v11
    ds_read_b64_tr_b16 v[64:65], v12 offset:0
    ds_read_b64_tr_b16 v[66:67], v12 offset:512
    ds_read_b64_tr_b16 v[68:69], v13 offset:0
    ds_read_b64_tr_b16 v[70:71], v13 offset:512
    ds_read_b64_tr_b16 v[72:73], v12 offset:2048
    ds_read_b64_tr_b16 v[74:75], v12 offset:2560
    ds_read_b64_tr_b16 v[76:77], v13 offset:2048
    ds_read_b64_tr_b16 v[78:79], v13 offset:2560
    ds_read_b64_tr_b16 v[80:81], v12 offset:4096
    ds_read_b64_tr_b16 v[82:83], v12 offset:4608
    ds_read_b64_tr_b16 v[84:85], v13 offset:4096
    ds_read_b64_tr_b16 v[86:87], v13 offset:4608
    s_waitcnt lgkmcnt(8)
    v_mfma_f32_32x32x16_bf16 v[16:31], v[64:67], a[0:3], 0
    s_add_u32 m0, s9, 98304
    s_add_u32 s77, s12, 128
    buffer_load_dwordx4 v97, s[52:55], s77 offen offset:0 lds
    v_mfma_f32_32x32x16_bf16 v[32:47], v[68:71], a[0:3], 0
    ds_read_b64_tr_b16 v[88:89], v12 offset:6144
    ds_read_b64_tr_b16 v[90:91], v12 offset:6656
    ds_read_b64_tr_b16 v[92:93], v13 offset:6144
    ds_read_b64_tr_b16 v[94:95], v13 offset:6656
    s_waitcnt lgkmcnt(8)
    v_mfma_f32_32x32x16_bf16 v[16:31], v[72:75], a[4:7], v[16:31]
    s_add_u32 s77, s77, 27648
    buffer_load_dwordx4 v97, s[52:55], s77 offen offset:1024 lds
    v_mfma_f32_32x32x16_bf16 v[32:47], v[76:79], a[4:7], v[32:47]
    ds_read_b64_tr_b16 v[64:65], v12 offset:8192
    ds_read_b64_tr_b16 v[66:67], v12 offset:8704
    ds_read_b64_tr_b16 v[68:69], v13 offset:8192
    ds_read_b64_tr_b16 v[70:71], v13 offset:8704
    s_waitcnt lgkmcnt(8)
    v_mfma_f32_32x32x16_bf16 v[16:31], v[80:83], a[8:11], v[16:31]
    s_add_u32 s77, s77, 27648
    buffer_load_dwordx4 v97, s[52:55], s77 offen offset:2048 lds
    v_mfma_f32_32x32x16_bf16 v[32:47], v[84:87], a[8:11], v[32:47]
    ds_read_b64_tr_b16 v[72:73], v12 offset:10240
    ds_read_b64_tr_b16 v[74:75], v12 offset:10752
    ds_read_b64_tr_b16 v[76:77], v13 offset:10240
    ds_read_b64_tr_b16 v[78:79], v13 offset:10752
    s_waitcnt lgkmcnt(8)
    v_mfma_f32_32x32x16_bf16 v[16:31], v[88:91], a[12:15], v[16:31]
    s_add_u32 s77, s77, 27648
    buffer_load_dwordx4 v97, s[52:55], s77 offen offset:3072 lds
    v_mfma_f32_32x32x16_bf16 v[32:47], v[92:95], a[12:15], v[32:47]
    ds_read_b64_tr_b16 v[80:81], v12 offset:12288
    ds_read_b64_tr_b16 v[82:83], v12 offset:12800
    ds_read_b64_tr_b16 v[84:85], v13 offset:12288
    ds_read_b64_tr_b16 v[86:87], v13 offset:12800
    s_waitcnt lgkmcnt(8)
    v_mfma_f32_32x32x16_bf16 v[16:31], v[64:67], a[16:19], v[16:31]
    s_add_u32 m0, s9, 114688
    s_add_u32 s77, s12, 458880
    buffer_load_dwordx4 v97, s[52:55], s77 offen offset:0 lds
    v_mfma_f32_32x32x16_bf16 v[32:47], v[68:71], a[16:19], v[32:47]
    ds_read_b64_tr_b16 v[88:89], v12 offset:14336
    ds_read_b64_tr_b16 v[90:91], v12 offset:14848
    ds_read_b64_tr_b16 v[92:93], v13 offset:14336
    ds_read_b64_tr_b16 v[94:95], v13 offset:14848
    s_waitcnt lgkmcnt(8)
    v_mfma_f32_32x32x16_bf16 v[16:31], v[72:75], a[20:23], v[16:31]
    s_add_u32 s77, s77, 27648
    buffer_load_dwordx4 v97, s[52:55], s77 offen offset:1024 lds
    v_mfma_f32_32x32x16_bf16 v[32:47], v[76:79], a[20:23], v[32:47]
    s_waitcnt lgkmcnt(4)
    v_mfma_f32_32x32x16_bf16 v[16:31], v[80:83], a[24:27], v[16:31]
    s_add_u32 s77, s77, 27648
    buffer_load_dwordx4 v97, s[52:55], s77 offen offset:2048 lds
    v_mfma_f32_32x32x16_bf16 v[32:47], v[84:87], a[24:27], v[32:47]
    s_waitcnt lgkmcnt(0)
    v_mfma_f32_32x32x16_bf16 v[16:31], v[88:91], a[28:31], v[16:31]
    s_add_u32 s77, s77, 27648
    buffer_load_dwordx4 v97, s[52:55], s77 offen offset:3072 lds
    v_mfma_f32_32x32x16_bf16 v[32:47], v[92:95], a[28:31], v[32:47]
    s_waitcnt vmcnt(9) lgkmcnt(0)
    s_barrier
    ds_read_b64_tr_b16 v[64:65], v10 offset:49152
    ds_read_b64_tr_b16 v[66:67], v10 offset:49664
    ds_read_b64_tr_b16 v[68:69], v11 offset:49152
    ds_read_b64_tr_b16 v[70:71], v11 offset:49664
    ds_read_b64_tr_b16 v[72:73], v10 offset:51200
    ds_read_b64_tr_b16 v[74:75], v10 offset:51712
    ds_read_b64_tr_b16 v[76:77], v11 offset:51200
    ds_read_b64_tr_b16 v[78:79], v11 offset:51712
    ds_read_b64_tr_b16 v[80:81], v10 offset:53248
    ds_read_b64_tr_b16 v[82:83], v10 offset:53760
    ds_read_b64_tr_b16 v[84:85], v11 offset:53248
    ds_read_b64_tr_b16 v[86:87], v11 offset:53760
    s_waitcnt lgkmcnt(8)
    v_mfma_f32_32x32x16_bf16 v[16:31], v[64:67], a[32:35], v[16:31]
    s_add_u32 m0, s9, 0
    s_add_u32 s77, s12, 917632
    buffer_load_dwordx4 v97, s[52:55], s77 offen offset:0 lds
    v_mfma_f32_32x32x16_bf16 v[32:47], v[68:71], a[32:35], v[32:47]
    ds_read_b64_tr_b16 v[88:89], v10 offset:55296
    ds_read_b64_tr_b16 v[90:91], v10 offset:55808
    ds_read_b64_tr_b16 v[92:93], v11 offset:55296
    ds_read_b64_tr_b16 v[94:95], v11 offset:55808
    s_waitcnt lgkmcnt(8)
    v_mfma_f32_32x32x16_bf16 v[16:31], v[72:75], a[36:39], v[16:31]
    s_add_u32 s77, s77, 27648
    buffer_load_dwordx4 v97, s[52:55], s77 offen offset:1024 lds
    v_mfma_f32_32x32x16_bf16 v[32:47], v[76:79], a[36:39], v[32:47]
    ds_read_b64_tr_b16 v[64:65], v10 offset:57344
    ds_read_b64_tr_b16 v[66:67], v10 offset:57856
    ds_read_b64_tr_b16 v[68:69], v11 offset:57344
    ds_read_b64_tr_b16 v[70:71], v11 offset:57856
    s_waitcnt lgkmcnt(8)
    v_mfma_f32_32x32x16_bf16 v[16:31], v[80:83], a[40:43], v[16:31]
    s_add_u32 s77, s77, 27648
    buffer_load_dwordx4 v97, s[52:55], s77 offen offset:2048 lds
    v_mfma_f32_32x32x16_bf16 v[32:47], v[84:87], a[40:43], v[32:47]
    ds_read_b64_tr_b16 v[72:73], v10 offset:59392
    ds_read_b64_tr_b16 v[74:75], v10 offset:59904
    ds_read_b64_tr_b16 v[76:77], v11 offset:59392
    ds_read_b64_tr_b16 v[78:79], v11 offset:59904
    s_waitcnt lgkmcnt(8)
    v_mfma_f32_32x32x16_bf16 v[16:31], v[88:91], a[44:47], v[16:31]
    s_add_u32 s77, s77, 27648
    buffer_load_dwordx4 v97, s[52:55], s77 offen offset:3072 lds
    v_mfma_f32_32x32x16_bf16 v[32:47], v[92:95], a[44:47], v[32:47]
    ds_read_b64_tr_b16 v[80:81], v10 offset:61440
    ds_read_b64_tr_b16 v[82:83], v10 offset:61952
    ds_read_b64_tr_b16 v[84:85], v11 offset:61440
    ds_read_b64_tr_b16 v[86:87], v11 offset:61952
    s_waitcnt lgkmcnt(8)
    v_mfma_f32_32x32x16_bf16 v[16:31], v[64:67], a[48:51], v[16:31]
    s_add_u32 m0, s9, 16384
    s_add_u32 s77, s12, 1376384
    buffer_load_dwordx4 v97, s[52:55], s77 offen offset:0 lds
    v_mfma_f32_32x32x16_bf16 v[32:47], v[68:71], a[48:51], v[32:47]
    ds_read_b64_tr_b16 v[88:89], v10 offset:63488
    ds_read_b64_tr_b16 v[90:91], v10 offset:64000
    ds_read_b64_tr_b16 v[92:93], v11 offset:63488
    ds_read_b64_tr_b16 v[94:95], v11 offset:64000
    s_waitcnt lgkmcnt(8)
    v_mfma_f32_32x32x16_bf16 v[16:31], v[72:75], a[52:55], v[16:31]
    s_add_u32 s77, s77, 27648
    buffer_load_dwordx4 v97, s[52:55], s77 offen offset:1024 lds
    v_mfma_f32_32x32x16_bf16 v[32:47], v[76:79], a[52:55], v[32:47]
    s_waitcnt lgkmcnt(4)
    v_mfma_f32_32x32x16_bf16 v[16:31], v[80:83], a[56:59], v[16:31]
    s_add_u32 s77, s77, 27648
    buffer_load_dwordx4 v97, s[52:55], s77 offen offset:2048 lds
    v_mfma_f32_32x32x16_bf16 v[32:47], v[84:87], a[56:59], v[32:47]
    s_waitcnt lgkmcnt(0)
    v_mfma_f32_32x32x16_bf16 v[16:31], v[88:91], a[60:63], v[16:31]
    s_add_u32 s77, s77, 27648
    buffer_load_dwordx4 v97, s[52:55], s77 offen offset:3072 lds
    v_mfma_f32_32x32x16_bf16 v[32:47], v[92:95], a[60:63], v[32:47]
    v_add_u32 v12, 65536, v10
    v_add_u32 v13, 65536, v11
    ds_read_b64_tr_b16 v[64:65], v12 offset:0
    ds_read_b64_tr_b16 v[66:67], v12 offset:512
    ds_read_b64_tr_b16 v[68:69], v13 offset:0
    ds_read_b64_tr_b16 v[70:71], v13 offset:512
    ds_read_b64_tr_b16 v[72:73], v12 offset:2048
    ds_read_b64_tr_b16 v[74:75], v12 offset:2560
    ds_read_b64_tr_b16 v[76:77], v13 offset:2048
    ds_read_b64_tr_b16 v[78:79], v13 offset:2560
    ds_read_b64_tr_b16 v[80:81], v12 offset:4096
    ds_read_b64_tr_b16 v[82:83], v12 offset:4608
    ds_read_b64_tr_b16 v[84:85], v13 offset:4096
    ds_read_b64_tr_b16 v[86:87], v13 offset:4608
    s_waitcnt lgkmcnt(8)
    v_mfma_f32_32x32x16_bf16 v[16:31], v[64:67], a[64:67], v[16:31]
    v_mfma_f32_32x32x16_bf16 v[32:47], v[68:71], a[64:67], v[32:47]
    ds_read_b64_tr_b16 v[88:89], v12 offset:6144
    ds_read_b64_tr_b16 v[90:91], v12 offset:6656
    ds_read_b64_tr_b16 v[92:93], v13 offset:6144
    ds_read_b64_tr_b16 v[94:95], v13 offset:6656
    s_waitcnt lgkmcnt(8)
    v_mfma_f32_32x32x16_bf16 v[16:31], v[72:75], a[68:71], v[16:31]
    v_mfma_f32_32x32x16_bf16 v[32:47], v[76:79], a[68:71], v[32:47]
    ds_read_b64_tr_b16 v[64:65], v12 offset:8192
    ds_read_b64_tr_b16 v[66:67], v12 offset:8704
    ds_read_b64_tr_b16 v[68:69], v13 offset:8192
    ds_read_b64_tr_b16 v[70:71], v13 offset:8704
    s_waitcnt lgkmcnt(8)
    v_mfma_f32_32x32x16_bf16 v[16:31], v[80:83], a[72:75], v[16:31]
    v_mfma_f32_32x32x16_bf16 v[32:47], v[84:87], a[72:75], v[32:47]
    ds_read_b64_tr_b16 v[72:73], v12 offset:10240
    ds_read_b64_tr_b16 v[74:75], v12 offset:10752
    ds_read_b64_tr_b16 v[76:77], v13 offset:10240
    ds_read_b64_tr_b16 v[78:79], v13 offset:10752
    s_waitcnt lgkmcnt(8)
    v_mfma_f32_32x32x16_bf16 v[16:31], v[88:91], a[76:79], v[16:31]
    v_mfma_f32_32x32x16_bf16 v[32:47], v[92:95], a[76:79], v[32:47]
    ds_read_b64_tr_b16 v[80:81], v12 offset:12288
    ds_read_b64_tr_b16 v[82:83], v12 offset:12800
    ds_read_b64_tr_b16 v[84:85], v13 offset:12288
    ds_read_b64_tr_b16 v[86:87], v13 offset:12800
    s_waitcnt lgkmcnt(8)
    v_mfma_f32_32x32x16_bf16 v[16:31], v[64:67], a[80:83], v[16:31]
    v_mfma_f32_32x32x16_bf16 v[32:47], v[68:71], a[80:83], v[32:47]
    ds_read_b64_tr_b16 v[88:89], v12 offset:14336
    ds_read_b64_tr_b16 v[90:91], v12 offset:14848
    ds_read_b64_tr_b16 v[92:93], v13 offset:14336
    ds_read_b64_tr_b16 v[94:95], v13 offset:14848
    s_waitcnt lgkmcnt(8)
    v_mfma_f32_32x32x16_bf16 v[16:31], v[72:75], a[84:87], v[16:31]
    v_mfma_f32_32x32x16_bf16 v[32:47], v[76:79], a[84:87], v[32:47]
    s_waitcnt lgkmcnt(4)
    v_mfma_f32_32x32x16_bf16 v[16:31], v[80:83], a[88:91], v[16:31]
    v_mfma_f32_32x32x16_bf16 v[32:47], v[84:87], a[88:91], v[32:47]
    s_waitcnt lgkmcnt(0)
    v_mfma_f32_32x32x16_bf16 v[16:31], v[88:91], a[92:95], v[16:31]
    v_mfma_f32_32x32x16_bf16 v[32:47], v[92:95], a[92:95], v[32:47]
    v_add_u32 v12, 81920, v10
    v_add_u32 v13, 81920, v11
    ds_read_b64_tr_b16 v[64:65], v12 offset:0
    ds_read_b64_tr_b16 v[66:67], v12 offset:512
    ds_read_b64_tr_b16 v[68:69], v13 offset:0
    ds_read_b64_tr_b16 v[70:71], v13 offset:512
    ds_read_b64_tr_b16 v[72:73], v12 offset:2048
    ds_read_b64_tr_b16 v[74:75], v12 offset:2560
    ds_read_b64_tr_b16 v[76:77], v13 offset:2048
    ds_read_b64_tr_b16 v[78:79], v13 offset:2560
    ds_read_b64_tr_b16 v[80:81], v12 offset:4096
    ds_read_b64_tr_b16 v[82:83], v12 offset:4608
    ds_read_b64_tr_b16 v[84:85], v13 offset:4096
    ds_read_b64_tr_b16 v[86:87], v13 offset:4608
    s_waitcnt lgkmcnt(8)
    v_mfma_f32_32x32x16_bf16 v[16:31], v[64:67], a[96:99], v[16:31]
    v_mfma_f32_32x32x16_bf16 v[32:47], v[68:71], a[96:99], v[32:47]
    ds_read_b64_tr_b16 v[88:89], v12 offset:6144
    ds_read_b64_tr_b16 v[90:91], v12 offset:6656
    ds_read_b64_tr_b16 v[92:93], v13 offset:6144
    ds_read_b64_tr_b16 v[94:95], v13 offset:6656
    s_waitcnt lgkmcnt(8)
    v_mfma_f32_32x32x16_bf16 v[16:31], v[72:75], a[100:103], v[16:31]
    v_mfma_f32_32x32x16_bf16 v[32:47], v[76:79], a[100:103], v[32:47]
    ds_read_b64_tr_b16 v[64:65], v12 offset:8192
    ds_read_b64_tr_b16 v[66:67], v12 offset:8704
    ds_read_b64_tr_b16 v[68:69], v13 offset:8192
    ds_read_b64_tr_b16 v[70:71], v13 offset:8704
    s_waitcnt lgkmcnt(8)
    v_mfma_f32_32x32x16_bf16 v[16:31], v[80:83], a[104:107], v[16:31]
    v_mfma_f32_32x32x16_bf16 v[32:47], v[84:87], a[104:107], v[32:47]
    ds_read_b64_tr_b16 v[72:73], v12 offset:10240
    ds_read_b64_tr_b16 v[74:75], v12 offset:10752
    ds_read_b64_tr_b16 v[76:77], v13 offset:10240
    ds_read_b64_tr_b16 v[78:79], v13 offset:10752
    s_waitcnt lgkmcnt(8)
    v_mfma_f32_32x32x16_bf16 v[16:31], v[88:91], a[108:111], v[16:31]
    v_mfma_f32_32x32x16_bf16 v[32:47], v[92:95], a[108:111], v[32:47]
    ds_read_b64_tr_b16 v[80:81], v12 offset:12288
    ds_read_b64_tr_b16 v[82:83], v12 offset:12800
    ds_read_b64_tr_b16 v[84:85], v13 offset:12288
    ds_read_b64_tr_b16 v[86:87], v13 offset:12800
    s_waitcnt lgkmcnt(8)
    v_mfma_f32_32x32x16_bf16 v[16:31], v[64:67], a[112:115], v[16:31]
    v_mfma_f32_32x32x16_bf16 v[32:47], v[68:71], a[112:115], v[32:47]
    ds_read_b64_tr_b16 v[88:89], v12 offset:14336
    ds_read_b64_tr_b16 v[90:91], v12 offset:14848
    ds_read_b64_tr_b16 v[92:93], v13 offset:14336
    ds_read_b64_tr_b16 v[94:95], v13 offset:14848
    s_waitcnt lgkmcnt(8)
    v_mfma_f32_32x32x16_bf16 v[16:31], v[72:75], a[116:119], v[16:31]
    v_mfma_f32_32x32x16_bf16 v[32:47], v[76:79], a[116:119], v[32:47]
    s_waitcnt lgkmcnt(4)
    v_mfma_f32_32x32x16_bf16 v[16:31], v[80:83], a[120:123], v[16:31]
    v_mfma_f32_32x32x16_bf16 v[32:47], v[84:87], a[120:123], v[32:47]
    s_waitcnt lgkmcnt(0)
    v_mfma_f32_32x32x16_bf16 v[16:31], v[88:91], a[124:127], v[16:31]
    v_mfma_f32_32x32x16_bf16 v[32:47], v[92:95], a[124:127], v[32:47]
    s_waitcnt vmcnt(0) lgkmcnt(0)
    s_barrier
    s_setprio 1
    s_mov_b32 s72, s40
    s_and_b32 s73, s41, 0xffff
    s_mov_b32 s74, 256
    s_mov_b32 s75, 0x20000
    v_mov_b32 v101, 0
    buffer_load_dword v101, v101, s[72:75], 0 offen sc1
    s_nop 7
    s_nop 3
    s_lshr_b32 s76, s7, 5
    s_lshl_b32 s76, s76, 10
    s_add_u32 s76, s76, s80
    v_add_u32 v13, 0x10000, v11
    ds_read_b64_tr_b16 v[64:65], v13 offset:32768
    ds_read_b64_tr_b16 v[66:67], v13 offset:33280
    ds_read_b64_tr_b16 v[68:69], v13 offset:34816
    ds_read_b64_tr_b16 v[70:71], v13 offset:35328
    ds_read_b64_tr_b16 v[72:73], v13 offset:36864
    ds_read_b64_tr_b16 v[74:75], v13 offset:37376
    ds_read_b64_tr_b16 v[76:77], v13 offset:38912
    ds_read_b64_tr_b16 v[78:79], v13 offset:39424
    ds_read_b64_tr_b16 v[80:81], v13 offset:40960
    ds_read_b64_tr_b16 v[82:83], v13 offset:41472
    ds_read_b64_tr_b16 v[84:85], v13 offset:43008
    ds_read_b64_tr_b16 v[86:87], v13 offset:43520
    ds_read_b64_tr_b16 v[88:89], v13 offset:45056
    ds_read_b64_tr_b16 v[90:91], v13 offset:45568
    s_nop 7
    v_cvt_pk_bf16_f32 v122, v16, v17
    v_cvt_pk_bf16_f32 v123, v18, v19
    v_cvt_pk_bf16_f32 v124, v20, v21
    v_cvt_pk_bf16_f32 v125, v22, v23
    v_lshlrev_b32 v16, 16, v122
    v_and_b32 v17, s20, v122
    v_lshlrev_b32 v18, 16, v123
    v_and_b32 v19, s20, v123
    v_lshlrev_b32 v20, 16, v124
    v_and_b32 v21, s20, v124
    v_lshlrev_b32 v22, 16, v125
    v_and_b32 v23, s20, v125
    v_mul_f32 v114, s16, v16
    v_mul_f32 v115, s16, v17
    v_mul_f32 v116, s16, v18
    v_mul_f32 v117, s16, v19
    v_mul_f32 v118, s16, v20
    v_mul_f32 v119, s16, v21
    v_mul_f32 v120, s16, v22
    v_mul_f32 v121, s16, v23
    v_exp_f32 v114, v114
    v_exp_f32 v115, v115
    v_exp_f32 v116, v116
    v_exp_f32 v117, v117
    v_exp_f32 v118, v118
    v_exp_f32 v119, v119
    v_exp_f32 v120, v120
    v_exp_f32 v121, v121
    v_add_f32 v114, 1.0, v114
    v_add_f32 v115, 1.0, v115
    v_add_f32 v116, 1.0, v116
    v_add_f32 v117, 1.0, v117
    v_add_f32 v118, 1.0, v118
    v_add_f32 v119, 1.0, v119
    v_add_f32 v120, 1.0, v120
    v_add_f32 v121, 1.0, v121
    v_rcp_f32 v114, v114
    v_rcp_f32 v115, v115
    v_rcp_f32 v116, v116
    v_rcp_f32 v117, v117
    v_rcp_f32 v118, v118
    v_rcp_f32 v119, v119
    v_rcp_f32 v120, v120
    v_rcp_f32 v121, v121
    v_mul_f32 v16, v16, v114
    v_mul_f32 v17, v17, v115
    v_mul_f32 v18, v18, v116
    v_mul_f32 v19, v19, v117
    v_mul_f32 v20, v20, v118
    v_mul_f32 v21, v21, v119
    v_mul_f32 v22, v22, v120
    v_mul_f32 v23, v23, v121
    v_cvt_pk_bf16_f32 v16, v16, v17
    v_cvt_pk_bf16_f32 v17, v18, v19
    v_cvt_pk_bf16_f32 v18, v20, v21
    v_cvt_pk_bf16_f32 v19, v22, v23
    buffer_store_dwordx4 v[16:19], v14, s[56:59], s76 offen offset:0 sc1
    v_cvt_pk_bf16_f32 v122, v24, v25
    v_cvt_pk_bf16_f32 v123, v26, v27
    v_cvt_pk_bf16_f32 v124, v28, v29
    v_cvt_pk_bf16_f32 v125, v30, v31
    v_lshlrev_b32 v24, 16, v122
    v_and_b32 v25, s20, v122
    v_lshlrev_b32 v26, 16, v123
    v_and_b32 v27, s20, v123
    v_lshlrev_b32 v28, 16, v124
    v_and_b32 v29, s20, v124
    v_lshlrev_b32 v30, 16, v125
    v_and_b32 v31, s20, v125
    v_mul_f32 v114, s16, v24
    v_mul_f32 v115, s16, v25
    v_mul_f32 v116, s16, v26
    v_mul_f32 v117, s16, v27
    v_mul_f32 v118, s16, v28
    v_mul_f32 v119, s16, v29
    v_mul_f32 v120, s16, v30
    v_mul_f32 v121, s16, v31
    v_exp_f32 v114, v114
    v_exp_f32 v115, v115
    v_exp_f32 v116, v116
    v_exp_f32 v117, v117
    v_exp_f32 v118, v118
    v_exp_f32 v119, v119
    v_exp_f32 v120, v120
    v_exp_f32 v121, v121
    v_add_f32 v114, 1.0, v114
    v_add_f32 v115, 1.0, v115
    v_add_f32 v116, 1.0, v116
    v_add_f32 v117, 1.0, v117
    v_add_f32 v118, 1.0, v118
    v_add_f32 v119, 1.0, v119
    v_add_f32 v120, 1.0, v120
    v_add_f32 v121, 1.0, v121
    v_rcp_f32 v114, v114
    v_rcp_f32 v115, v115
    v_rcp_f32 v116, v116
    v_rcp_f32 v117, v117
    v_rcp_f32 v118, v118
    v_rcp_f32 v119, v119
    v_rcp_f32 v120, v120
    v_rcp_f32 v121, v121
    v_mul_f32 v24, v24, v114
    v_mul_f32 v25, v25, v115
    v_mul_f32 v26, v26, v116
    v_mul_f32 v27, v27, v117
    v_mul_f32 v28, v28, v118
    v_mul_f32 v29, v29, v119
    v_mul_f32 v30, v30, v120
    v_mul_f32 v31, v31, v121
    v_cvt_pk_bf16_f32 v24, v24, v25
    v_cvt_pk_bf16_f32 v25, v26, v27
    v_cvt_pk_bf16_f32 v26, v28, v29
    v_cvt_pk_bf16_f32 v27, v30, v31
    buffer_store_dwordx4 v[24:27], v14, s[56:59], s76 offen offset:1024 sc1
    v_cvt_pk_bf16_f32 v122, v32, v33
    v_cvt_pk_bf16_f32 v123, v34, v35
    v_cvt_pk_bf16_f32 v124, v36, v37
    v_cvt_pk_bf16_f32 v125, v38, v39
    v_lshlrev_b32 v32, 16, v122
    v_and_b32 v33, s20, v122
    v_lshlrev_b32 v34, 16, v123
    v_and_b32 v35, s20, v123
    v_lshlrev_b32 v36, 16, v124
    v_and_b32 v37, s20, v124
    v_lshlrev_b32 v38, 16, v125
    v_and_b32 v39, s20, v125
    v_mul_f32 v114, s16, v32
    v_mul_f32 v115, s16, v33
    v_mul_f32 v116, s16, v34
    v_mul_f32 v117, s16, v35
    v_mul_f32 v118, s16, v36
    v_mul_f32 v119, s16, v37
    v_mul_f32 v120, s16, v38
    v_mul_f32 v121, s16, v39
    v_exp_f32 v114, v114
    v_exp_f32 v115, v115
    v_exp_f32 v116, v116
    v_exp_f32 v117, v117
    v_exp_f32 v118, v118
    v_exp_f32 v119, v119
    v_exp_f32 v120, v120
    v_exp_f32 v121, v121
    v_add_f32 v114, 1.0, v114
    v_add_f32 v115, 1.0, v115
    v_add_f32 v116, 1.0, v116
    v_add_f32 v117, 1.0, v117
    v_add_f32 v118, 1.0, v118
    v_add_f32 v119, 1.0, v119
    v_add_f32 v120, 1.0, v120
    v_add_f32 v121, 1.0, v121
    v_rcp_f32 v114, v114
    v_rcp_f32 v115, v115
    v_rcp_f32 v116, v116
    v_rcp_f32 v117, v117
    v_rcp_f32 v118, v118
    v_rcp_f32 v119, v119
    v_rcp_f32 v120, v120
    v_rcp_f32 v121, v121
    v_mul_f32 v32, v32, v114
    v_mul_f32 v33, v33, v115
    v_mul_f32 v34, v34, v116
    v_mul_f32 v35, v35, v117
    v_mul_f32 v36, v36, v118
    v_mul_f32 v37, v37, v119
    v_mul_f32 v38, v38, v120
    v_mul_f32 v39, v39, v121
    v_cvt_pk_bf16_f32 v32, v32, v33
    v_cvt_pk_bf16_f32 v33, v34, v35
    v_cvt_pk_bf16_f32 v34, v36, v37
    v_cvt_pk_bf16_f32 v35, v38, v39
    buffer_store_dwordx4 v[32:35], v14, s[56:59], s76 offen offset:2048 sc1
    v_cvt_pk_bf16_f32 v122, v40, v41
    v_cvt_pk_bf16_f32 v123, v42, v43
    v_cvt_pk_bf16_f32 v124, v44, v45
    v_cvt_pk_bf16_f32 v125, v46, v47
    v_lshlrev_b32 v40, 16, v122
    v_and_b32 v41, s20, v122
    v_lshlrev_b32 v42, 16, v123
    v_and_b32 v43, s20, v123
    v_lshlrev_b32 v44, 16, v124
    v_and_b32 v45, s20, v124
    v_lshlrev_b32 v46, 16, v125
    v_and_b32 v47, s20, v125
    v_mul_f32 v114, s16, v40
    v_mul_f32 v115, s16, v41
    v_mul_f32 v116, s16, v42
    v_mul_f32 v117, s16, v43
    v_mul_f32 v118, s16, v44
    v_mul_f32 v119, s16, v45
    v_mul_f32 v120, s16, v46
    v_mul_f32 v121, s16, v47
    v_exp_f32 v114, v114
    v_exp_f32 v115, v115
    v_exp_f32 v116, v116
    v_exp_f32 v117, v117
    v_exp_f32 v118, v118
    v_exp_f32 v119, v119
    v_exp_f32 v120, v120
    v_exp_f32 v121, v121
    v_add_f32 v114, 1.0, v114
    v_add_f32 v115, 1.0, v115
    v_add_f32 v116, 1.0, v116
    v_add_f32 v117, 1.0, v117
    v_add_f32 v118, 1.0, v118
    v_add_f32 v119, 1.0, v119
    v_add_f32 v120, 1.0, v120
    v_add_f32 v121, 1.0, v121
    v_rcp_f32 v114, v114
    v_rcp_f32 v115, v115
    v_rcp_f32 v116, v116
    v_rcp_f32 v117, v117
    v_rcp_f32 v118, v118
    v_rcp_f32 v119, v119
    v_rcp_f32 v120, v120
    v_rcp_f32 v121, v121
    v_mul_f32 v40, v40, v114
    v_mul_f32 v41, v41, v115
    v_mul_f32 v42, v42, v116
    v_mul_f32 v43, v43, v117
    v_mul_f32 v44, v44, v118
    v_mul_f32 v45, v45, v119
    v_mul_f32 v46, v46, v120
    v_mul_f32 v47, v47, v121
    v_cvt_pk_bf16_f32 v40, v40, v41
    v_cvt_pk_bf16_f32 v41, v42, v43
    v_cvt_pk_bf16_f32 v42, v44, v45
    v_cvt_pk_bf16_f32 v43, v46, v47
    buffer_store_dwordx4 v[40:43], v14, s[56:59], s76 offen offset:3072 sc1
    s_waitcnt lgkmcnt(12)
    v_mfma_f32_32x32x16_bf16 v[48:63], v[64:67], a[0:3], 0
    ds_read_b64_tr_b16 v[92:93], v13 offset:47104
    ds_read_b64_tr_b16 v[94:95], v13 offset:47616
    s_waitcnt lgkmcnt(12)
    v_mfma_f32_32x32x16_bf16 v[48:63], v[68:71], a[4:7], v[48:63]
    ds_read_b64_tr_b16 v[64:65], v13 offset:49152
    ds_read_b64_tr_b16 v[66:67], v13 offset:49664
    s_waitcnt lgkmcnt(12)
    v_mfma_f32_32x32x16_bf16 v[48:63], v[72:75], a[8:11], v[48:63]
    ds_read_b64_tr_b16 v[68:69], v13 offset:51200
    ds_read_b64_tr_b16 v[70:71], v13 offset:51712
    s_waitcnt lgkmcnt(12)
    v_mfma_f32_32x32x16_bf16 v[48:63], v[76:79], a[12:15], v[48:63]
    ds_read_b64_tr_b16 v[72:73], v13 offset:53248
    ds_read_b64_tr_b16 v[74:75], v13 offset:53760
    s_waitcnt lgkmcnt(12)
    v_mfma_f32_32x32x16_bf16 v[48:63], v[80:83], a[16:19], v[48:63]
    ds_read_b64_tr_b16 v[76:77], v13 offset:55296
    ds_read_b64_tr_b16 v[78:79], v13 offset:55808
    s_waitcnt lgkmcnt(12)
    v_mfma_f32_32x32x16_bf16 v[48:63], v[84:87], a[20:23], v[48:63]
    ds_read_b64_tr_b16 v[80:81], v13 offset:57344
    ds_read_b64_tr_b16 v[82:83], v13 offset:57856
    s_waitcnt lgkmcnt(12)
    v_mfma_f32_32x32x16_bf16 v[48:63], v[88:91], a[24:27], v[48:63]
    ds_read_b64_tr_b16 v[84:85], v13 offset:59392
    ds_read_b64_tr_b16 v[86:87], v13 offset:59904
    s_waitcnt lgkmcnt(12)
    v_mfma_f32_32x32x16_bf16 v[48:63], v[92:95], a[28:31], v[48:63]
    ds_read_b64_tr_b16 v[88:89], v13 offset:61440
    ds_read_b64_tr_b16 v[90:91], v13 offset:61952
    s_waitcnt lgkmcnt(12)
    v_mfma_f32_32x32x16_bf16 v[48:63], v[64:67], a[32:35], v[48:63]
    ds_read_b64_tr_b16 v[92:93], v13 offset:63488
    ds_read_b64_tr_b16 v[94:95], v13 offset:64000
    s_waitcnt lgkmcnt(12)
    v_mfma_f32_32x32x16_bf16 v[48:63], v[68:71], a[36:39], v[48:63]
    ds_read_b64_tr_b16 v[64:65], v11 offset:0
    ds_read_b64_tr_b16 v[66:67], v11 offset:512
    s_waitcnt lgkmcnt(12)
    v_mfma_f32_32x32x16_bf16 v[48:63], v[72:75], a[40:43], v[48:63]
    ds_read_b64_tr_b16 v[68:69], v11 offset:2048
    ds_read_b64_tr_b16 v[70:71], v11 offset:2560
    s_waitcnt lgkmcnt(12)
    v_mfma_f32_32x32x16_bf16 v[48:63], v[76:79], a[44:47], v[48:63]
    ds_read_b64_tr_b16 v[72:73], v11 offset:4096
    ds_read_b64_tr_b16 v[74:75], v11 offset:4608
    s_waitcnt lgkmcnt(12)
    v_mfma_f32_32x32x16_bf16 v[48:63], v[80:83], a[48:51], v[48:63]
    ds_read_b64_tr_b16 v[76:77], v11 offset:6144
    ds_read_b64_tr_b16 v[78:79], v11 offset:6656
    s_waitcnt lgkmcnt(12)
    v_mfma_f32_32x32x16_bf16 v[48:63], v[84:87], a[52:55], v[48:63]
    ds_read_b64_tr_b16 v[80:81], v11 offset:8192
    ds_read_b64_tr_b16 v[82:83], v11 offset:8704
    s_waitcnt lgkmcnt(12)
    v_mfma_f32_32x32x16_bf16 v[48:63], v[88:91], a[56:59], v[48:63]
    ds_read_b64_tr_b16 v[84:85], v11 offset:10240
    ds_read_b64_tr_b16 v[86:87], v11 offset:10752
    s_waitcnt lgkmcnt(12)
    v_mfma_f32_32x32x16_bf16 v[48:63], v[92:95], a[60:63], v[48:63]
    ds_read_b64_tr_b16 v[88:89], v11 offset:12288
    ds_read_b64_tr_b16 v[90:91], v11 offset:12800
    s_waitcnt lgkmcnt(12)
    v_mfma_f32_32x32x16_bf16 v[48:63], v[64:67], a[64:67], v[48:63]
    ds_read_b64_tr_b16 v[92:93], v11 offset:14336
    ds_read_b64_tr_b16 v[94:95], v11 offset:14848
    s_waitcnt lgkmcnt(12)
    v_mfma_f32_32x32x16_bf16 v[48:63], v[68:71], a[68:71], v[48:63]
    ds_read_b64_tr_b16 v[64:65], v11 offset:16384
    ds_read_b64_tr_b16 v[66:67], v11 offset:16896
    s_waitcnt lgkmcnt(12)
    v_mfma_f32_32x32x16_bf16 v[48:63], v[72:75], a[72:75], v[48:63]
    ds_read_b64_tr_b16 v[68:69], v11 offset:18432
    ds_read_b64_tr_b16 v[70:71], v11 offset:18944
    s_waitcnt lgkmcnt(12)
    v_mfma_f32_32x32x16_bf16 v[48:63], v[76:79], a[76:79], v[48:63]
    ds_read_b64_tr_b16 v[72:73], v11 offset:20480
    ds_read_b64_tr_b16 v[74:75], v11 offset:20992
    s_waitcnt lgkmcnt(12)
    v_mfma_f32_32x32x16_bf16 v[48:63], v[80:83], a[80:83], v[48:63]
    ds_read_b64_tr_b16 v[76:77], v11 offset:22528
    ds_read_b64_tr_b16 v[78:79], v11 offset:23040
    s_waitcnt lgkmcnt(12)
    v_mfma_f32_32x32x16_bf16 v[48:63], v[84:87], a[84:87], v[48:63]
    ds_read_b64_tr_b16 v[80:81], v11 offset:24576
    ds_read_b64_tr_b16 v[82:83], v11 offset:25088
    s_waitcnt lgkmcnt(12)
    v_mfma_f32_32x32x16_bf16 v[48:63], v[88:91], a[88:91], v[48:63]
    ds_read_b64_tr_b16 v[84:85], v11 offset:26624
    ds_read_b64_tr_b16 v[86:87], v11 offset:27136
    s_waitcnt lgkmcnt(12)
    v_mfma_f32_32x32x16_bf16 v[48:63], v[92:95], a[92:95], v[48:63]
    ds_read_b64_tr_b16 v[88:89], v11 offset:28672
    ds_read_b64_tr_b16 v[90:91], v11 offset:29184
    s_waitcnt lgkmcnt(12)
    v_mfma_f32_32x32x16_bf16 v[48:63], v[64:67], a[96:99], v[48:63]
    ds_read_b64_tr_b16 v[92:93], v11 offset:30720
    ds_read_b64_tr_b16 v[94:95], v11 offset:31232
    s_waitcnt lgkmcnt(12)
    v_mfma_f32_32x32x16_bf16 v[48:63], v[68:71], a[100:103], v[48:63]
    s_waitcnt lgkmcnt(10)
    v_mfma_f32_32x32x16_bf16 v[48:63], v[72:75], a[104:107], v[48:63]
    s_waitcnt lgkmcnt(8)
    v_mfma_f32_32x32x16_bf16 v[48:63], v[76:79], a[108:111], v[48:63]
    s_waitcnt lgkmcnt(6)
    v_mfma_f32_32x32x16_bf16 v[48:63], v[80:83], a[112:115], v[48:63]
    s_waitcnt lgkmcnt(4)
    v_mfma_f32_32x32x16_bf16 v[48:63], v[84:87], a[116:119], v[48:63]
    s_waitcnt lgkmcnt(2)
    v_mfma_f32_32x32x16_bf16 v[48:63], v[88:91], a[120:123], v[48:63]
    s_waitcnt lgkmcnt(0)
    v_mfma_f32_32x32x16_bf16 v[48:63], v[92:95], a[124:127], v[48:63]
    s_nop 7
    s_nop 7
    s_add_u32 s76, s76, 6144
    v_cvt_pk_bf16_f32 v122, v48, v49
    v_cvt_pk_bf16_f32 v123, v50, v51
    v_cvt_pk_bf16_f32 v124, v52, v53
    v_cvt_pk_bf16_f32 v125, v54, v55
    v_lshlrev_b32 v48, 16, v122
    v_and_b32 v49, s20, v122
    v_lshlrev_b32 v50, 16, v123
    v_and_b32 v51, s20, v123
    v_lshlrev_b32 v52, 16, v124
    v_and_b32 v53, s20, v124
    v_lshlrev_b32 v54, 16, v125
    v_and_b32 v55, s20, v125
    v_pk_mul_f32 v[114:115], v[48:49], s[16:17]
    v_pk_mul_f32 v[116:117], v[50:51], s[16:17]
    v_pk_mul_f32 v[118:119], v[52:53], s[16:17]
    v_pk_mul_f32 v[120:121], v[54:55], s[16:17]
    v_exp_f32 v114, v114
    v_exp_f32 v115, v115
    v_exp_f32 v116, v116
    v_exp_f32 v117, v117
    v_exp_f32 v118, v118
    v_exp_f32 v119, v119
    v_exp_f32 v120, v120
    v_exp_f32 v121, v121
    v_pk_add_f32 v[114:115], v[114:115], s[18:19]
    v_pk_add_f32 v[116:117], v[116:117], s[18:19]
    v_pk_add_f32 v[118:119], v[118:119], s[18:19]
    v_pk_add_f32 v[120:121], v[120:121], s[18:19]
    v_rcp_f32 v114, v114
    v_rcp_f32 v115, v115
    v_rcp_f32 v116, v116
    v_rcp_f32 v117, v117
    v_rcp_f32 v118, v118
    v_rcp_f32 v119, v119
    v_rcp_f32 v120, v120
    v_rcp_f32 v121, v121
    s_nop 0
    v_pk_mul_f32 v[48:49], v[48:49], v[114:115]
    v_pk_mul_f32 v[50:51], v[50:51], v[116:117]
    v_pk_mul_f32 v[52:53], v[52:53], v[118:119]
    v_pk_mul_f32 v[54:55], v[54:55], v[120:121]
    v_cvt_pk_bf16_f32 v48, v48, v49
    v_cvt_pk_bf16_f32 v49, v50, v51
    v_cvt_pk_bf16_f32 v50, v52, v53
    v_cvt_pk_bf16_f32 v51, v54, v55
    buffer_store_dwordx4 v[48:51], v14, s[56:59], s76 offen offset:0 sc1
    v_cvt_pk_bf16_f32 v122, v56, v57
    v_cvt_pk_bf16_f32 v123, v58, v59
    v_cvt_pk_bf16_f32 v124, v60, v61
    v_cvt_pk_bf16_f32 v125, v62, v63
    v_lshlrev_b32 v56, 16, v122
    v_and_b32 v57, s20, v122
    v_lshlrev_b32 v58, 16, v123
    v_and_b32 v59, s20, v123
    v_lshlrev_b32 v60, 16, v124
    v_and_b32 v61, s20, v124
    v_lshlrev_b32 v62, 16, v125
    v_and_b32 v63, s20, v125
    v_pk_mul_f32 v[114:115], v[56:57], s[16:17]
    v_pk_mul_f32 v[116:117], v[58:59], s[16:17]
    v_pk_mul_f32 v[118:119], v[60:61], s[16:17]
    v_pk_mul_f32 v[120:121], v[62:63], s[16:17]
    v_exp_f32 v114, v114
    v_exp_f32 v115, v115
    v_exp_f32 v116, v116
    v_exp_f32 v117, v117
    v_exp_f32 v118, v118
    v_exp_f32 v119, v119
    v_exp_f32 v120, v120
    v_exp_f32 v121, v121
    v_pk_add_f32 v[114:115], v[114:115], s[18:19]
    v_pk_add_f32 v[116:117], v[116:117], s[18:19]
    v_pk_add_f32 v[118:119], v[118:119], s[18:19]
    v_pk_add_f32 v[120:121], v[120:121], s[18:19]
    v_rcp_f32 v114, v114
    v_rcp_f32 v115, v115
    v_rcp_f32 v116, v116
    v_rcp_f32 v117, v117
    v_rcp_f32 v118, v118
    v_rcp_f32 v119, v119
    v_rcp_f32 v120, v120
    v_rcp_f32 v121, v121
    s_nop 0
    v_pk_mul_f32 v[56:57], v[56:57], v[114:115]
    v_pk_mul_f32 v[58:59], v[58:59], v[116:117]
    v_pk_mul_f32 v[60:61], v[60:61], v[118:119]
    v_pk_mul_f32 v[62:63], v[62:63], v[120:121]
    v_cvt_pk_bf16_f32 v56, v56, v57
    v_cvt_pk_bf16_f32 v57, v58, v59
    v_cvt_pk_bf16_f32 v58, v60, v61
    v_cvt_pk_bf16_f32 v59, v62, v63
    buffer_store_dwordx4 v[56:59], v14, s[56:59], s76 offen offset:1024 sc1
KB_P2:
    s_load_dwordx2 s[16:17], s[0:1], 0
    s_load_dwordx2 s[18:19], s[0:1], 64
    s_load_dwordx2 s[20:21], s[0:1], 104
    s_and_b32 s24, s2, 7
    s_lshr_b32 s25, s2, 3
    s_lshl_b32 s22, s24, 2
    s_lshr_b32 s26, s25, 3
    s_add_u32 s22, s22, s26
    s_and_b32 s23, s25, 7
    s_lshl_b32 s26, s4, 3
    s_lshr_b32 s28, 0xc1511, s26
    s_and_b32 s28, s28, 0xff
    s_lshr_b32 s29, 0x11090000, s26
    s_and_b32 s29, s29, 0xff
    s_lshr_b32 s30, 0x88582800, s26
    s_and_b32 s30, s30, 0xff
    s_lshl_b32 s30, s30, 10
    s_lshr_b32 s32, 0xb0885828, s26
    s_and_b32 s32, s32, 0xff
    s_lshl_b32 s32, s32, 10
    s_mul_i32 s26, s22, 360448
    s_mul_i32 s27, s23, 360448
    s_add_u32 s27, s27, 11534336
    s_add_u32 s44, s42, s27
    s_addc_u32 s45, s43, 0
    s_and_b32 s45, s45, 0xffff
    s_mov_b32 s46, s32
    s_mov_b32 s47, 0x20000
    s_add_u32 s52, s42, s27
    s_addc_u32 s53, s43, 0
    s_add_u32 s52, s52, 180224
    s_addc_u32 s53, s53, 0
    s_and_b32 s53, s53, 0xffff
    s_mov_b32 s54, s32
    s_mov_b32 s55, 0x20000
    s_add_u32 s48, s42, s26
    s_addc_u32 s49, s43, 0
    s_and_b32 s49, s49, 0xffff
    s_mov_b32 s50, s32
    s_mov_b32 s51, 0x20000
    s_add_u32 s60, s42, s26
    s_addc_u32 s61, s43, 0
    s_add_u32 s60, s60, 180224
    s_addc_u32 s61, s61, 0
    s_and_b32 s61, s61, 0xffff
    s_mov_b32 s62, s32
    s_mov_b32 s63, 0x20000
    s_waitcnt lgkmcnt(0)
    s_lshl_b32 s26, s4, 6
    v_add_u32 v13, s26, v0
    v_lshrrev_b32 v15, 4, v13
    v_and_b32 v13, 15, v13
    v_bfe_u32 v9, v15, 2, 1
    v_lshlrev_b32 v9, 4, v9
    v_and_b32 v10, 1, v15
    v_lshl_add_u32 v9, v10, 3, v9
    v_lshrrev_b32 v10, 3, v15
    v_lshl_add_u32 v9, v10, 1, v9
    v_bfe_u32 v10, v15, 1, 1
    v_add_u32 v9, v9, v10
    s_lshl_b32 s26, s22, 6
    v_add_u32 v9, s26, v9
    s_lshl_b32 s27, s23, 7
    v_lshlrev_b32 v10, 10, v9
    v_lshl_add_u32 v10, v13, 3, v10
    v_add_u32 v10, s27, v10
    v_lshlrev_b32 v11, 2, v9
    v_lshlrev_b32 v12, 3, v13
    v_add_u32 v12, s27, v12
    s_lshl_b32 s27, s27, 1
    v_lshlrev_b32 v9, 11, v9
    v_lshl_add_u32 v9, v13, 4, v9
    v_add_u32 v9, s27, v9
    s_mov_b32 s64, s16
    s_and_b32 s65, s17, 0xffff
    s_mov_b32 s66, 2097152
    s_mov_b32 s67, 0x20000
    s_mov_b32 s68, s18
    s_and_b32 s69, s19, 0xffff
    s_mov_b32 s70, 1024
    s_mov_b32 s71, 0x20000
    s_mov_b32 s72, s20
    s_and_b32 s73, s21, 0xffff
    s_mov_b32 s74, 4194304
    s_mov_b32 s75, 0x20000
    s_mov_b32 s26, 0
    buffer_load_dwordx2 v[120:121], v10, s[64:67], s26 offen
    s_mov_b32 s26, 4096
    buffer_load_dwordx2 v[122:123], v10, s[64:67], s26 offen
    buffer_load_dwordx2 v[6:7], v12, s[68:71], 0 offen
    s_cmp_lg_u32 s4, 0
    s_cbranch_scc1 P2_NOWL
    v_lshlrev_b32 v13, 7, v0
    s_mov_b32 s26, 14647296
    buffer_load_dword v8, v13, s[56:59], s26 offen sc1
    s_waitcnt vmcnt(4)
    s_branch P2_WL2
P2_NOWL:
    s_waitcnt vmcnt(3)
P2_WL2:
    v_readfirstlane_b32 s33, v101
    s_mov_b32 s81, 0
    s_nop 2
P2_NL:
    s_cmp_lg_u32 s33, 0
    s_cbranch_scc1 P2_NOK
    s_add_u32 s81, s81, 1
    s_cmp_gt_u32 s81, 300000
    s_cbranch_scc1 P2_NOK
    s_mov_b32 s84, s40
    s_and_b32 s85, s41, 0xffff
    s_mov_b32 s86, 256
    s_mov_b32 s87, 0x20000
    v_mov_b32 v101, 0
    buffer_load_dword v101, v101, s[84:87], 0 offen sc1
    s_waitcnt vmcnt(0)
    v_readfirstlane_b32 s33, v101
    s_nop 3
    s_branch P2_NL
P2_NOK:
    s_mov_b32 s34, 0
    s_barrier
    s_cmp_lg_u32 s4, 0
    s_cbranch_scc1 P2_NOPUB
    s_lshl_b32 s26, s5, 4
    s_add_u32 s26, s26, s6
    s_lshl_b32 s26, s26, 7
    s_add_u32 s26, s26, 14614528
    v_mov_b32 v13, 0
    v_mov_b32 v15, s33
    s_mov_b64 exec, 1
    buffer_store_dword v15, v13, s[56:59], s26 offen sc1
    s_mov_b64 exec, -1
P2_NOPUB:
    s_cmp_lg_u32 s34, 0
    s_cbranch_scc1 P2_WDONE
    s_cmp_eq_u32 s4, 0
    s_cbranch_scc1 P2_W1
    s_waitcnt vmcnt(0)
    s_branch P2_WFOK
P2_W1:
    s_waitcnt vmcnt(1)
    v_cmp_ne_u32 vcc, s33, v8
    s_nop 4
    s_cbranch_vccz P2_WFOK
    s_mov_b32 s81, 0
    v_lshlrev_b32 v13, 7, v0
    s_mov_b32 s26, 14647296
P2_WF:
    buffer_load_dword v15, v13, s[56:59], s26 offen sc1
    s_waitcnt vmcnt(0)
    v_cmp_ne_u32 vcc, s33, v15
    s_add_u32 s81, s81, 1
    s_cmp_gt_u32 s81, 300000
    s_cbranch_scc1 P2_WFOK
    s_nop 1
    s_cbranch_vccz P2_WFOK
    s_sleep 4
    s_branch P2_WF
P2_WFOK:
    s_barrier
    s_add_u32 s31, s30, 4096
    buffer_load_dwordx4 v[16:19], v14, s[44:47], s30 offen offset:0 sc1
    buffer_load_dwordx4 v[24:27], v14, s[52:55], s30 offen offset:0 sc1
    buffer_load_dwordx4 v[32:35], v14, s[44:47], s30 offen offset:1024 sc1
    buffer_load_dwordx4 v[40:43], v14, s[52:55], s30 offen offset:1024 sc1
    buffer_load_dwordx4 v[48:51], v14, s[44:47], s30 offen offset:2048 sc1
    buffer_load_dwordx4 v[56:59], v14, s[52:55], s30 offen offset:2048 sc1
    buffer_load_dwordx4 v[64:67], v14, s[44:47], s30 offen offset:3072 sc1
    buffer_load_dwordx4 v[72:75], v14, s[52:55], s30 offen offset:3072 sc1
    buffer_load_dwordx4 v[80:83], v14, s[44:47], s31 offen offset:0 sc1
    buffer_load_dwordx4 v[88:91], v14, s[52:55], s31 offen offset:0 sc1
    buffer_load_dwordx4 v[96:99], v14, s[44:47], s31 offen offset:1024 sc1
    buffer_load_dwordx4 v[104:107], v14, s[52:55], s31 offen offset:1024 sc1
P2_WDONE:
    s_lshr_b32 s35, s22, 1
    s_lshl_b32 s35, s35, 11
    s_add_u32 s35, s35, 14614528
    v_and_b32 v2, 15, v0
    v_lshlrev_b32 v2, 7, v2
    s_cmp_lg_u32 s4, 0
    s_cbranch_scc1 P2_NOLOOK
    buffer_load_dword v12, v2, s[56:59], s35 offen sc1
P2_NOLOOK:
    s_mul_i32 s36, s4, 12288
    s_add_u32 s36, s36, 98304
    s_add_u32 m0, s36, 0
    s_add_u32 s37, s30, 6144
    buffer_load_dwordx4 v14, s[44:47], s37 offen offset:0 sc1 lds
    buffer_load_dwordx4 v14, s[44:47], s37 offen offset:1024 sc1 lds
    buffer_load_dwordx4 v14, s[44:47], s37 offen offset:2048 sc1 lds
    buffer_load_dwordx4 v14, s[44:47], s37 offen offset:3072 sc1 lds
    s_add_u32 m0, s36, 4096
    s_add_u32 s37, s30, 10240
    buffer_load_dwordx4 v14, s[44:47], s37 offen offset:0 sc1 lds
    buffer_load_dwordx4 v14, s[44:47], s37 offen offset:1024 sc1 lds
    s_add_u32 m0, s36, 6144
    s_add_u32 s37, s30, 6144
    buffer_load_dwordx4 v14, s[52:55], s37 offen offset:0 sc1 lds
    buffer_load_dwordx4 v14, s[52:55], s37 offen offset:1024 sc1 lds
    buffer_load_dwordx4 v14, s[52:55], s37 offen offset:2048 sc1 lds
    buffer_load_dwordx4 v14, s[52:55], s37 offen offset:3072 sc1 lds
    s_add_u32 m0, s36, 10240
    s_add_u32 s37, s30, 10240
    buffer_load_dwordx4 v14, s[52:55], s37 offen offset:0 sc1 lds
    buffer_load_dwordx4 v14, s[52:55], s37 offen offset:1024 sc1 lds
    v_add_u32 v10, s36, v14
    v_lshlrev_b32 v108, 16, v6
    v_and_b32 v109, 0xffff0000, v6
    v_lshlrev_b32 v110, 16, v7
    v_and_b32 v111, 0xffff0000, v7
    v_lshlrev_b32 v13, 16, v120
    v_and_b32 v15, 0xffff0000, v120
    v_lshlrev_b32 v5, 16, v121
    v_and_b32 v8, 0xffff0000, v121
    v_mul_f32 v13, v13, v108
    v_mul_f32 v15, v15, v109
    v_mul_f32 v5, v5, v110
    v_mul_f32 v8, v8, v111
    v_cvt_pk_bf16_f32 v13, v13, v15
    v_cvt_pk_bf16_f32 v5, v5, v8
    v_lshlrev_b32 v112, 16, v13
    v_and_b32 v113, 0xffff0000, v13
    v_lshlrev_b32 v114, 16, v5
    v_and_b32 v115, 0xffff0000, v5
    v_lshlrev_b32 v13, 16, v122
    v_and_b32 v15, 0xffff0000, v122
    v_lshlrev_b32 v5, 16, v123
    v_and_b32 v8, 0xffff0000, v123
    v_mul_f32 v13, v13, v108
    v_mul_f32 v15, v15, v109
    v_mul_f32 v5, v5, v110
    v_mul_f32 v8, v8, v111
    v_cvt_pk_bf16_f32 v13, v13, v15
    v_cvt_pk_bf16_f32 v5, v5, v8
    v_lshlrev_b32 v116, 16, v13
    v_and_b32 v117, 0xffff0000, v13
    v_lshlrev_b32 v118, 16, v5
    v_and_b32 v119, 0xffff0000, v5
    v_mov_b32 v108, 0
    v_mov_b32 v109, 0
    v_mov_b32 v110, 0
    v_mov_b32 v111, 0
    s_nop 1
    v_mfma_f32_32x32x16_bf16 a[0:15], v[108:111], v[108:111], 0
    v_mfma_f32_32x32x16_bf16 a[16:31], v[108:111], v[108:111], 0
    v_mfma_f32_32x32x16_bf16 a[32:47], v[108:111], v[108:111], 0
    v_mfma_f32_32x32x16_bf16 a[48:63], v[108:111], v[108:111], 0
    v_mfma_f32_32x32x16_bf16 a[64:79], v[108:111], v[108:111], 0
    v_mfma_f32_32x32x16_bf16 a[80:95], v[108:111], v[108:111], 0
    v_mfma_f32_32x32x16_bf16 a[96:111], v[108:111], v[108:111], 0
    v_mfma_f32_32x32x16_bf16 a[112:127], v[108:111], v[108:111], 0
    s_mov_b32 s81, 0
    s_cmp_lg_u32 s4, 0
    s_cbranch_scc1 P2_CFOK
    s_waitcnt vmcnt(12)
    s_branch P2_CF1
P2_CF:
    s_waitcnt vmcnt(0)
P2_CF1:
    v_cmp_ne_u32 vcc, s33, v12
    s_add_u32 s81, s81, 1
    s_cmp_gt_u32 s81, 300000
    s_cbranch_scc1 P2_CFOK
    s_nop 1
    s_cbranch_vccz P2_CFOK
    buffer_load_dword v12, v2, s[56:59], s35 offen sc1
    s_branch P2_CF
P2_CFOK:
    s_barrier
    buffer_load_dwordx4 v[20:23], v14, s[48:51], s30 offen offset:0 sc1
    buffer_load_dwordx4 v[28:31], v14, s[60:63], s30 offen offset:0 sc1
    buffer_load_dwordx4 v[36:39], v14, s[48:51], s30 offen offset:1024 sc1
    buffer_load_dwordx4 v[44:47], v14, s[60:63], s30 offen offset:1024 sc1
    buffer_load_dwordx4 v[52:55], v14, s[48:51], s30 offen offset:2048 sc1
    buffer_load_dwordx4 v[60:63], v14, s[60:63], s30 offen offset:2048 sc1
    buffer_load_dwordx4 v[68:71], v14, s[48:51], s30 offen offset:3072 sc1
    buffer_load_dwordx4 v[76:79], v14, s[60:63], s30 offen offset:3072 sc1
    buffer_load_dwordx4 v[84:87], v14, s[48:51], s31 offen offset:0 sc1
    buffer_load_dwordx4 v[92:95], v14, s[60:63], s31 offen offset:0 sc1
    buffer_load_dwordx4 v[100:103], v14, s[48:51], s31 offen offset:1024 sc1
    buffer_load_dwordx4 v[108:111], v14, s[60:63], s31 offen offset:1024 sc1
    s_mov_b32 s26, 14417920
    buffer_load_dword v1, v11, s[56:59], s26 offen offset:0 sc1
    buffer_load_dword v2, v11, s[56:59], s26 offen offset:16 sc1
    s_add_u32 s30, s30, 6144
    s_cmp_eq_u32 s4, 3
    s_cbranch_scc1 P2_FY
    s_waitcnt vmcnt(12)
    v_mfma_f32_32x32x16_bf16 a[0:15], v[16:19], v[20:23], a[0:15]
    v_mfma_f32_32x32x16_bf16 a[16:31], v[16:19], v[28:31], a[16:31]
    ds_read_b128 v[16:19], v10 offset:0
    v_mfma_f32_32x32x16_bf16 a[32:47], v[24:27], v[20:23], a[32:47]
    buffer_load_dwordx4 v[20:23], v14, s[48:51], s30 offen offset:0 sc1
    v_mfma_f32_32x32x16_bf16 a[48:63], v[24:27], v[28:31], a[48:63]
    ds_read_b128 v[24:27], v10 offset:6144
    buffer_load_dwordx4 v[28:31], v14, s[60:63], s30 offen offset:0 sc1
    s_waitcnt vmcnt(12)
    v_mfma_f32_32x32x16_bf16 a[0:15], v[32:35], v[36:39], a[0:15]
    v_mfma_f32_32x32x16_bf16 a[16:31], v[32:35], v[44:47], a[16:31]
    ds_read_b128 v[32:35], v10 offset:1024
    v_mfma_f32_32x32x16_bf16 a[32:47], v[40:43], v[36:39], a[32:47]
    buffer_load_dwordx4 v[36:39], v14, s[48:51], s30 offen offset:1024 sc1
    v_mfma_f32_32x32x16_bf16 a[48:63], v[40:43], v[44:47], a[48:63]
    ds_read_b128 v[40:43], v10 offset:7168
    buffer_load_dwordx4 v[44:47], v14, s[60:63], s30 offen offset:1024 sc1
    s_add_u32 s30, s30, 2048
    s_waitcnt vmcnt(12)
    v_mfma_f32_32x32x16_bf16 a[0:15], v[48:51], v[52:55], a[0:15]
    v_mfma_f32_32x32x16_bf16 a[16:31], v[48:51], v[60:63], a[16:31]
    ds_read_b128 v[48:51], v10 offset:2048
    v_mfma_f32_32x32x16_bf16 a[32:47], v[56:59], v[52:55], a[32:47]
    buffer_load_dwordx4 v[52:55], v14, s[48:51], s30 offen offset:0 sc1
    v_mfma_f32_32x32x16_bf16 a[48:63], v[56:59], v[60:63], a[48:63]
    ds_read_b128 v[56:59], v10 offset:8192
    buffer_load_dwordx4 v[60:63], v14, s[60:63], s30 offen offset:0 sc1
    s_waitcnt vmcnt(12)
    v_mfma_f32_32x32x16_bf16 a[0:15], v[64:67], v[68:71], a[0:15]
    v_mfma_f32_32x32x16_bf16 a[16:31], v[64:67], v[76:79], a[16:31]
    ds_read_b128 v[64:67], v10 offset:3072
    v_mfma_f32_32x32x16_bf16 a[32:47], v[72:75], v[68:71], a[32:47]
    buffer_load_dwordx4 v[68:71], v14, s[48:51], s30 offen offset:1024 sc1
    v_mfma_f32_32x32x16_bf16 a[48:63], v[72:75], v[76:79], a[48:63]
    ds_read_b128 v[72:75], v10 offset:9216
    buffer_load_dwordx4 v[76:79], v14, s[60:63], s30 offen offset:1024 sc1
    s_add_u32 s30, s30, 2048
    s_waitcnt vmcnt(12)
    v_mfma_f32_32x32x16_bf16 a[0:15], v[80:83], v[84:87], a[0:15]
    v_mfma_f32_32x32x16_bf16 a[16:31], v[80:83], v[92:95], a[16:31]
    ds_read_b128 v[80:83], v10 offset:4096
    v_mfma_f32_32x32x16_bf16 a[32:47], v[88:91], v[84:87], a[32:47]
    buffer_load_dwordx4 v[84:87], v14, s[48:51], s30 offen offset:0 sc1
    v_mfma_f32_32x32x16_bf16 a[48:63], v[88:91], v[92:95], a[48:63]
    ds_read_b128 v[88:91], v10 offset:10240
    buffer_load_dwordx4 v[92:95], v14, s[60:63], s30 offen offset:0 sc1
    s_waitcnt vmcnt(12)
    v_mfma_f32_32x32x16_bf16 a[0:15], v[96:99], v[100:103], a[0:15]
    v_mfma_f32_32x32x16_bf16 a[16:31], v[96:99], v[108:111], a[16:31]
    ds_read_b128 v[96:99], v10 offset:5120
    v_mfma_f32_32x32x16_bf16 a[32:47], v[104:107], v[100:103], a[32:47]
    buffer_load_dwordx4 v[100:103], v14, s[48:51], s30 offen offset:1024 sc1
    v_mfma_f32_32x32x16_bf16 a[48:63], v[104:107], v[108:111], a[48:63]
    ds_read_b128 v[104:107], v10 offset:11264
    buffer_load_dwordx4 v[108:111], v14, s[60:63], s30 offen offset:1024 sc1
    s_add_u32 s30, s30, 2048
    s_waitcnt vmcnt(10) lgkmcnt(10)
    v_mfma_f32_32x32x16_bf16 a[0:15], v[16:19], v[20:23], a[0:15]
    v_mfma_f32_32x32x16_bf16 a[16:31], v[16:19], v[28:31], a[16:31]
    buffer_load_dwordx4 v[16:19], v14, s[44:47], s30 offen offset:0 sc1
    v_mfma_f32_32x32x16_bf16 a[32:47], v[24:27], v[20:23], a[32:47]
    buffer_load_dwordx4 v[20:23], v14, s[48:51], s30 offen offset:0 sc1
    v_mfma_f32_32x32x16_bf16 a[48:63], v[24:27], v[28:31], a[48:63]
    buffer_load_dwordx4 v[24:27], v14, s[52:55], s30 offen offset:0 sc1
    buffer_load_dwordx4 v[28:31], v14, s[60:63], s30 offen offset:0 sc1
    s_waitcnt vmcnt(12) lgkmcnt(8)
    v_mfma_f32_32x32x16_bf16 a[0:15], v[32:35], v[36:39], a[0:15]
    v_mfma_f32_32x32x16_bf16 a[16:31], v[32:35], v[44:47], a[16:31]
    buffer_load_dwordx4 v[32:35], v14, s[44:47], s30 offen offset:1024 sc1
    v_mfma_f32_32x32x16_bf16 a[32:47], v[40:43], v[36:39], a[32:47]
    buffer_load_dwordx4 v[36:39], v14, s[48:51], s30 offen offset:1024 sc1
    v_mfma_f32_32x32x16_bf16 a[48:63], v[40:43], v[44:47], a[48:63]
    buffer_load_dwordx4 v[40:43], v14, s[52:55], s30 offen offset:1024 sc1
    buffer_load_dwordx4 v[44:47], v14, s[60:63], s30 offen offset:1024 sc1
    s_add_u32 s30, s30, 2048
    s_waitcnt vmcnt(14) lgkmcnt(6)
    v_mfma_f32_32x32x16_bf16 a[0:15], v[48:51], v[52:55], a[0:15]
    v_mfma_f32_32x32x16_bf16 a[16:31], v[48:51], v[60:63], a[16:31]
    buffer_load_dwordx4 v[48:51], v14, s[44:47], s30 offen offset:0 sc1
    v_mfma_f32_32x32x16_bf16 a[32:47], v[56:59], v[52:55], a[32:47]
    buffer_load_dwordx4 v[52:55], v14, s[48:51], s30 offen offset:0 sc1
    v_mfma_f32_32x32x16_bf16 a[48:63], v[56:59], v[60:63], a[48:63]
    buffer_load_dwordx4 v[56:59], v14, s[52:55], s30 offen offset:0 sc1
    buffer_load_dwordx4 v[60:63], v14, s[60:63], s30 offen offset:0 sc1
    s_waitcnt vmcnt(16) lgkmcnt(4)
    v_mfma_f32_32x32x16_bf16 a[0:15], v[64:67], v[68:71], a[0:15]
    v_mfma_f32_32x32x16_bf16 a[16:31], v[64:67], v[76:79], a[16:31]
    buffer_load_dwordx4 v[64:67], v14, s[44:47], s30 offen offset:1024 sc1
    v_mfma_f32_32x32x16_bf16 a[32:47], v[72:75], v[68:71], a[32:47]
    buffer_load_dwordx4 v[68:71], v14, s[48:51], s30 offen offset:1024 sc1
    v_mfma_f32_32x32x16_bf16 a[48:63], v[72:75], v[76:79], a[48:63]
    buffer_load_dwordx4 v[72:75], v14, s[52:55], s30 offen offset:1024 sc1
    buffer_load_dwordx4 v[76:79], v14, s[60:63], s30 offen offset:1024 sc1
    s_add_u32 s30, s30, 2048
    s_waitcnt vmcnt(18) lgkmcnt(2)
    v_mfma_f32_32x32x16_bf16 a[0:15], v[80:83], v[84:87], a[0:15]
    v_mfma_f32_32x32x16_bf16 a[16:31], v[80:83], v[92:95], a[16:31]
    buffer_load_dwordx4 v[80:83], v14, s[44:47], s30 offen offset:0 sc1
    v_mfma_f32_32x32x16_bf16 a[32:47], v[88:91], v[84:87], a[32:47]
    buffer_load_dwordx4 v[84:87], v14, s[48:51], s30 offen offset:0 sc1
    v_mfma_f32_32x32x16_bf16 a[48:63], v[88:91], v[92:95], a[48:63]
    buffer_load_dwordx4 v[88:91], v14, s[52:55], s30 offen offset:0 sc1
    buffer_load_dwordx4 v[92:95], v14, s[60:63], s30 offen offset:0 sc1
    s_waitcnt vmcnt(20) lgkmcnt(0)
    v_mfma_f32_32x32x16_bf16 a[0:15], v[96:99], v[100:103], a[0:15]
    v_mfma_f32_32x32x16_bf16 a[16:31], v[96:99], v[108:111], a[16:31]
    buffer_load_dwordx4 v[96:99], v14, s[44:47], s30 offen offset:1024 sc1
    v_mfma_f32_32x32x16_bf16 a[32:47], v[104:107], v[100:103], a[32:47]
    buffer_load_dwordx4 v[100:103], v14, s[48:51], s30 offen offset:1024 sc1
    v_mfma_f32_32x32x16_bf16 a[48:63], v[104:107], v[108:111], a[48:63]
    buffer_load_dwordx4 v[104:107], v14, s[52:55], s30 offen offset:1024 sc1
    buffer_load_dwordx4 v[108:111], v14, s[60:63], s30 offen offset:1024 sc1
    s_add_u32 s30, s30, 2048
    s_sub_u32 s28, s28, 6
    s_branch P2_L
P2_FY:
    s_waitcnt vmcnt(12)
    v_mfma_f32_32x32x16_bf16 a[64:79], v[16:19], v[20:23], a[64:79]
    v_mfma_f32_32x32x16_bf16 a[80:95], v[16:19], v[28:31], a[80:95]
    ds_read_b128 v[16:19], v10 offset:0
    v_mfma_f32_32x32x16_bf16 a[96:111], v[24:27], v[20:23], a[96:111]
    buffer_load_dwordx4 v[20:23], v14, s[48:51], s30 offen offset:0 sc1
    v_mfma_f32_32x32x16_bf16 a[112:127], v[24:27], v[28:31], a[112:127]
    ds_read_b128 v[24:27], v10 offset:6144
    buffer_load_dwordx4 v[28:31], v14, s[60:63], s30 offen offset:0 sc1
    s_waitcnt vmcnt(12)
    v_mfma_f32_32x32x16_bf16 a[64:79], v[32:35], v[36:39], a[64:79]
    v_mfma_f32_32x32x16_bf16 a[80:95], v[32:35], v[44:47], a[80:95]
    ds_read_b128 v[32:35], v10 offset:1024
    v_mfma_f32_32x32x16_bf16 a[96:111], v[40:43], v[36:39], a[96:111]
    buffer_load_dwordx4 v[36:39], v14, s[48:51], s30 offen offset:1024 sc1
    v_mfma_f32_32x32x16_bf16 a[112:127], v[40:43], v[44:47], a[112:127]
    ds_read_b128 v[40:43], v10 offset:7168
    buffer_load_dwordx4 v[44:47], v14, s[60:63], s30 offen offset:1024 sc1
    s_add_u32 s30, s30, 2048
    s_waitcnt vmcnt(12)
    v_mfma_f32_32x32x16_bf16 a[64:79], v[48:51], v[52:55], a[64:79]
    v_mfma_f32_32x32x16_bf16 a[80:95], v[48:51], v[60:63], a[80:95]
    ds_read_b128 v[48:51], v10 offset:2048
    v_mfma_f32_32x32x16_bf16 a[96:111], v[56:59], v[52:55], a[96:111]
    buffer_load_dwordx4 v[52:55], v14, s[48:51], s30 offen offset:0 sc1
    v_mfma_f32_32x32x16_bf16 a[112:127], v[56:59], v[60:63], a[112:127]
    ds_read_b128 v[56:59], v10 offset:8192
    buffer_load_dwordx4 v[60:63], v14, s[60:63], s30 offen offset:0 sc1
    s_waitcnt vmcnt(12)
    v_mfma_f32_32x32x16_bf16 a[64:79], v[64:67], v[68:71], a[64:79]
    v_mfma_f32_32x32x16_bf16 a[80:95], v[64:67], v[76:79], a[80:95]
    ds_read_b128 v[64:67], v10 offset:3072
    v_mfma_f32_32x32x16_bf16 a[96:111], v[72:75], v[68:71], a[96:111]
    buffer_load_dwordx4 v[68:71], v14, s[48:51], s30 offen offset:1024 sc1
    v_mfma_f32_32x32x16_bf16 a[112:127], v[72:75], v[76:79], a[112:127]
    ds_read_b128 v[72:75], v10 offset:9216
    buffer_load_dwordx4 v[76:79], v14, s[60:63], s30 offen offset:1024 sc1
    s_add_u32 s30, s30, 2048
    s_waitcnt vmcnt(12)
    v_mfma_f32_32x32x16_bf16 a[64:79], v[80:83], v[84:87], a[64:79]
    v_mfma_f32_32x32x16_bf16 a[80:95], v[80:83], v[92:95], a[80:95]
    ds_read_b128 v[80:83], v10 offset:4096
    v_mfma_f32_32x32x16_bf16 a[96:111], v[88:91], v[84:87], a[96:111]
    buffer_load_dwordx4 v[84:87], v14, s[48:51], s30 offen offset:0 sc1
    v_mfma_f32_32x32x16_bf16 a[112:127], v[88:91], v[92:95], a[112:127]
    ds_read_b128 v[88:91], v10 offset:10240
    buffer_load_dwordx4 v[92:95], v14, s[60:63], s30 offen offset:0 sc1
    s_waitcnt vmcnt(12)
    v_mfma_f32_32x32x16_bf16 a[64:79], v[96:99], v[100:103], a[64:79]
    v_mfma_f32_32x32x16_bf16 a[80:95], v[96:99], v[108:111], a[80:95]
    ds_read_b128 v[96:99], v10 offset:5120
    v_mfma_f32_32x32x16_bf16 a[96:111], v[104:107], v[100:103], a[96:111]
    buffer_load_dwordx4 v[100:103], v14, s[48:51], s30 offen offset:1024 sc1
    v_mfma_f32_32x32x16_bf16 a[112:127], v[104:107], v[108:111], a[112:127]
    ds_read_b128 v[104:107], v10 offset:11264
    buffer_load_dwordx4 v[108:111], v14, s[60:63], s30 offen offset:1024 sc1
    s_add_u32 s30, s30, 2048
    s_waitcnt vmcnt(10) lgkmcnt(10)
    v_mfma_f32_32x32x16_bf16 a[64:79], v[16:19], v[20:23], a[64:79]
    v_mfma_f32_32x32x16_bf16 a[80:95], v[16:19], v[28:31], a[80:95]
    buffer_load_dwordx4 v[16:19], v14, s[44:47], s30 offen offset:0 sc1
    v_mfma_f32_32x32x16_bf16 a[96:111], v[24:27], v[20:23], a[96:111]
    buffer_load_dwordx4 v[20:23], v14, s[48:51], s30 offen offset:0 sc1
    v_mfma_f32_32x32x16_bf16 a[112:127], v[24:27], v[28:31], a[112:127]
    buffer_load_dwordx4 v[24:27], v14, s[52:55], s30 offen offset:0 sc1
    buffer_load_dwordx4 v[28:31], v14, s[60:63], s30 offen offset:0 sc1
    s_waitcnt vmcnt(12) lgkmcnt(8)
    v_mfma_f32_32x32x16_bf16 a[64:79], v[32:35], v[36:39], a[64:79]
    v_mfma_f32_32x32x16_bf16 a[80:95], v[32:35], v[44:47], a[80:95]
    buffer_load_dwordx4 v[32:35], v14, s[44:47], s30 offen offset:1024 sc1
    v_mfma_f32_32x32x16_bf16 a[96:111], v[40:43], v[36:39], a[96:111]
    buffer_load_dwordx4 v[36:39], v14, s[48:51], s30 offen offset:1024 sc1
    v_mfma_f32_32x32x16_bf16 a[112:127], v[40:43], v[44:47], a[112:127]
    buffer_load_dwordx4 v[40:43], v14, s[52:55], s30 offen offset:1024 sc1
    buffer_load_dwordx4 v[44:47], v14, s[60:63], s30 offen offset:1024 sc1
    s_add_u32 s30, s30, 2048
    s_waitcnt vmcnt(14) lgkmcnt(6)
    v_mfma_f32_32x32x16_bf16 a[64:79], v[48:51], v[52:55], a[64:79]
    v_mfma_f32_32x32x16_bf16 a[80:95], v[48:51], v[60:63], a[80:95]
    buffer_load_dwordx4 v[48:51], v14, s[44:47], s30 offen offset:0 sc1
    v_mfma_f32_32x32x16_bf16 a[96:111], v[56:59], v[52:55], a[96:111]
    buffer_load_dwordx4 v[52:55], v14, s[48:51], s30 offen offset:0 sc1
    v_mfma_f32_32x32x16_bf16 a[112:127], v[56:59], v[60:63], a[112:127]
    buffer_load_dwordx4 v[56:59], v14, s[52:55], s30 offen offset:0 sc1
    buffer_load_dwordx4 v[60:63], v14, s[60:63], s30 offen offset:0 sc1
    s_waitcnt vmcnt(16) lgkmcnt(4)
    v_mfma_f32_32x32x16_bf16 a[64:79], v[64:67], v[68:71], a[64:79]
    v_mfma_f32_32x32x16_bf16 a[80:95], v[64:67], v[76:79], a[80:95]
    buffer_load_dwordx4 v[64:67], v14, s[44:47], s30 offen offset:1024 sc1
    v_mfma_f32_32x32x16_bf16 a[96:111], v[72:75], v[68:71], a[96:111]
    buffer_load_dwordx4 v[68:71], v14, s[48:51], s30 offen offset:1024 sc1
    v_mfma_f32_32x32x16_bf16 a[112:127], v[72:75], v[76:79], a[112:127]
    buffer_load_dwordx4 v[72:75], v14, s[52:55], s30 offen offset:1024 sc1
    buffer_load_dwordx4 v[76:79], v14, s[60:63], s30 offen offset:1024 sc1
    s_add_u32 s30, s30, 2048
    s_waitcnt vmcnt(18) lgkmcnt(2)
    v_mfma_f32_32x32x16_bf16 a[64:79], v[80:83], v[84:87], a[64:79]
    v_mfma_f32_32x32x16_bf16 a[80:95], v[80:83], v[92:95], a[80:95]
    buffer_load_dwordx4 v[80:83], v14, s[44:47], s30 offen offset:0 sc1
    v_mfma_f32_32x32x16_bf16 a[96:111], v[88:91], v[84:87], a[96:111]
    buffer_load_dwordx4 v[84:87], v14, s[48:51], s30 offen offset:0 sc1
    v_mfma_f32_32x32x16_bf16 a[112:127], v[88:91], v[92:95], a[112:127]
    buffer_load_dwordx4 v[88:91], v14, s[52:55], s30 offen offset:0 sc1
    buffer_load_dwordx4 v[92:95], v14, s[60:63], s30 offen offset:0 sc1
    s_waitcnt vmcnt(20) lgkmcnt(0)
    v_mfma_f32_32x32x16_bf16 a[64:79], v[96:99], v[100:103], a[64:79]
    v_mfma_f32_32x32x16_bf16 a[80:95], v[96:99], v[108:111], a[80:95]
    buffer_load_dwordx4 v[96:99], v14, s[44:47], s30 offen offset:1024 sc1
    v_mfma_f32_32x32x16_bf16 a[96:111], v[104:107], v[100:103], a[96:111]
    buffer_load_dwordx4 v[100:103], v14, s[48:51], s30 offen offset:1024 sc1
    v_mfma_f32_32x32x16_bf16 a[112:127], v[104:107], v[108:111], a[112:127]
    buffer_load_dwordx4 v[104:107], v14, s[52:55], s30 offen offset:1024 sc1
    buffer_load_dwordx4 v[108:111], v14, s[60:63], s30 offen offset:1024 sc1
    s_add_u32 s30, s30, 2048
    s_sub_u32 s29, s29, 6
P2_L:
    s_cmp_eq_u32 s28, 0
    s_cbranch_scc1 P2_LB_done
P2_LB:
    s_waitcnt vmcnt(20)
    v_mfma_f32_32x32x16_bf16 a[0:15], v[16:19], v[20:23], a[0:15]
    v_mfma_f32_32x32x16_bf16 a[16:31], v[16:19], v[28:31], a[16:31]
    buffer_load_dwordx4 v[16:19], v14, s[44:47], s30 offen offset:0 sc1
    v_mfma_f32_32x32x16_bf16 a[32:47], v[24:27], v[20:23], a[32:47]
    buffer_load_dwordx4 v[20:23], v14, s[48:51], s30 offen offset:0 sc1
    v_mfma_f32_32x32x16_bf16 a[48:63], v[24:27], v[28:31], a[48:63]
    buffer_load_dwordx4 v[24:27], v14, s[52:55], s30 offen offset:0 sc1
    buffer_load_dwordx4 v[28:31], v14, s[60:63], s30 offen offset:0 sc1
    s_waitcnt vmcnt(20)
    v_mfma_f32_32x32x16_bf16 a[0:15], v[32:35], v[36:39], a[0:15]
    v_mfma_f32_32x32x16_bf16 a[16:31], v[32:35], v[44:47], a[16:31]
    buffer_load_dwordx4 v[32:35], v14, s[44:47], s30 offen offset:1024 sc1
    v_mfma_f32_32x32x16_bf16 a[32:47], v[40:43], v[36:39], a[32:47]
    buffer_load_dwordx4 v[36:39], v14, s[48:51], s30 offen offset:1024 sc1
    v_mfma_f32_32x32x16_bf16 a[48:63], v[40:43], v[44:47], a[48:63]
    buffer_load_dwordx4 v[40:43], v14, s[52:55], s30 offen offset:1024 sc1
    buffer_load_dwordx4 v[44:47], v14, s[60:63], s30 offen offset:1024 sc1
    s_add_u32 s30, s30, 2048
    s_sub_u32 s28, s28, 1
    s_cmp_eq_u32 s28, 0
    s_cbranch_scc1 P2_LB_done
    s_waitcnt vmcnt(20)
    v_mfma_f32_32x32x16_bf16 a[0:15], v[48:51], v[52:55], a[0:15]
    v_mfma_f32_32x32x16_bf16 a[16:31], v[48:51], v[60:63], a[16:31]
    buffer_load_dwordx4 v[48:51], v14, s[44:47], s30 offen offset:0 sc1
    v_mfma_f32_32x32x16_bf16 a[32:47], v[56:59], v[52:55], a[32:47]
    buffer_load_dwordx4 v[52:55], v14, s[48:51], s30 offen offset:0 sc1
    v_mfma_f32_32x32x16_bf16 a[48:63], v[56:59], v[60:63], a[48:63]
    buffer_load_dwordx4 v[56:59], v14, s[52:55], s30 offen offset:0 sc1
    buffer_load_dwordx4 v[60:63], v14, s[60:63], s30 offen offset:0 sc1
    s_waitcnt vmcnt(20)
    v_mfma_f32_32x32x16_bf16 a[0:15], v[64:67], v[68:71], a[0:15]
    v_mfma_f32_32x32x16_bf16 a[16:31], v[64:67], v[76:79], a[16:31]
    buffer_load_dwordx4 v[64:67], v14, s[44:47], s30 offen offset:1024 sc1
    v_mfma_f32_32x32x16_bf16 a[32:47], v[72:75], v[68:71], a[32:47]
    buffer_load_dwordx4 v[68:71], v14, s[48:51], s30 offen offset:1024 sc1
    v_mfma_f32_32x32x16_bf16 a[48:63], v[72:75], v[76:79], a[48:63]
    buffer_load_dwordx4 v[72:75], v14, s[52:55], s30 offen offset:1024 sc1
    buffer_load_dwordx4 v[76:79], v14, s[60:63], s30 offen offset:1024 sc1
    s_add_u32 s30, s30, 2048
    s_sub_u32 s28, s28, 1
    s_cmp_eq_u32 s28, 0
    s_cbranch_scc1 P2_LB_done
    s_waitcnt vmcnt(20)
    v_mfma_f32_32x32x16_bf16 a[0:15], v[80:83], v[84:87], a[0:15]
    v_mfma_f32_32x32x16_bf16 a[16:31], v[80:83], v[92:95], a[16:31]
    buffer_load_dwordx4 v[80:83], v14, s[44:47], s30 offen offset:0 sc1
    v_mfma_f32_32x32x16_bf16 a[32:47], v[88:91], v[84:87], a[32:47]
    buffer_load_dwordx4 v[84:87], v14, s[48:51], s30 offen offset:0 sc1
    v_mfma_f32_32x32x16_bf16 a[48:63], v[88:91], v[92:95], a[48:63]
    buffer_load_dwordx4 v[88:91], v14, s[52:55], s30 offen offset:0 sc1
    buffer_load_dwordx4 v[92:95], v14, s[60:63], s30 offen offset:0 sc1
    s_waitcnt vmcnt(20)
    v_mfma_f32_32x32x16_bf16 a[0:15], v[96:99], v[100:103], a[0:15]
    v_mfma_f32_32x32x16_bf16 a[16:31], v[96:99], v[108:111], a[16:31]
    buffer_load_dwordx4 v[96:99], v14, s[44:47], s30 offen offset:1024 sc1
    v_mfma_f32_32x32x16_bf16 a[32:47], v[104:107], v[100:103], a[32:47]
    buffer_load_dwordx4 v[100:103], v14, s[48:51], s30 offen offset:1024 sc1
    v_mfma_f32_32x32x16_bf16 a[48:63], v[104:107], v[108:111], a[48:63]
    buffer_load_dwordx4 v[104:107], v14, s[52:55], s30 offen offset:1024 sc1
    buffer_load_dwordx4 v[108:111], v14, s[60:63], s30 offen offset:1024 sc1
    s_add_u32 s30, s30, 2048
    s_sub_u32 s28, s28, 1
    s_cmp_lg_u32 s28, 0
    s_cbranch_scc1 P2_LB
P2_LB_done:
    s_cmp_lg_u32 s4, 2
    s_cbranch_scc1 P2_NOE2
    v_and_b32 v13, 31, v0
    v_lshrrev_b32 v15, 5, v0
    v_mul_u32_u24 v13, 272, v13
    v_lshl_add_u32 v13, v15, 4, v13
    s_mul_i32 s26, s4, 17408
    v_add_u32 v13, s26, v13
    s_nop 7
    ds_write_b128 v13, a[0:3] offset:0
    ds_write_b128 v13, a[4:7] offset:32
    ds_write_b128 v13, a[8:11] offset:64
    ds_write_b128 v13, a[12:15] offset:96
    ds_write_b128 v13, a[16:19] offset:8704
    ds_write_b128 v13, a[20:23] offset:8736
    ds_write_b128 v13, a[24:27] offset:8768
    ds_write_b128 v13, a[28:31] offset:8800
    ds_write_b128 v13, a[32:35] offset:128
    ds_write_b128 v13, a[36:39] offset:160
    ds_write_b128 v13, a[40:43] offset:192
    ds_write_b128 v13, a[44:47] offset:224
    ds_write_b128 v13, a[48:51] offset:8832
    ds_write_b128 v13, a[52:55] offset:8864
    ds_write_b128 v13, a[56:59] offset:8896
    ds_write_b128 v13, a[60:63] offset:8928
P2_NOE2:
    v_sub_f32 v5, 1.0, v1
    v_cvt_pk_bf16_f32 v5, v5, v5
    v_and_b32 v5, 0xffff0000, v5
    v_sub_f32 v6, 1.0, v2
    v_cvt_pk_bf16_f32 v6, v6, v6
    v_and_b32 v6, 0xffff0000, v6
    v_mul_f32 v112, v1, v112
    v_mul_f32 v113, v1, v113
    v_mul_f32 v114, v1, v114
    v_mul_f32 v115, v1, v115
    v_add_f32 v1, v1, v1
    v_mul_f32 v116, v2, v116
    v_mul_f32 v117, v2, v117
    v_mul_f32 v118, v2, v118
    v_mul_f32 v119, v2, v119
    v_add_f32 v2, v2, v2
    s_cmp_eq_u32 s29, 0
    s_cbranch_scc1 P2_LY_done
P2_LY:
    s_waitcnt vmcnt(20)
    v_mfma_f32_32x32x16_bf16 a[64:79], v[16:19], v[20:23], a[64:79]
    v_mfma_f32_32x32x16_bf16 a[80:95], v[16:19], v[28:31], a[80:95]
    buffer_load_dwordx4 v[16:19], v14, s[44:47], s30 offen offset:0 sc1
    v_mfma_f32_32x32x16_bf16 a[96:111], v[24:27], v[20:23], a[96:111]
    buffer_load_dwordx4 v[20:23], v14, s[48:51], s30 offen offset:0 sc1
    v_mfma_f32_32x32x16_bf16 a[112:127], v[24:27], v[28:31], a[112:127]
    buffer_load_dwordx4 v[24:27], v14, s[52:55], s30 offen offset:0 sc1
    buffer_load_dwordx4 v[28:31], v14, s[60:63], s30 offen offset:0 sc1
    s_waitcnt vmcnt(20)
    v_mfma_f32_32x32x16_bf16 a[64:79], v[32:35], v[36:39], a[64:79]
    v_mfma_f32_32x32x16_bf16 a[80:95], v[32:35], v[44:47], a[80:95]
    buffer_load_dwordx4 v[32:35], v14, s[44:47], s30 offen offset:1024 sc1
    v_mfma_f32_32x32x16_bf16 a[96:111], v[40:43], v[36:39], a[96:111]
    buffer_load_dwordx4 v[36:39], v14, s[48:51], s30 offen offset:1024 sc1
    v_mfma_f32_32x32x16_bf16 a[112:127], v[40:43], v[44:47], a[112:127]
    buffer_load_dwordx4 v[40:43], v14, s[52:55], s30 offen offset:1024 sc1
    buffer_load_dwordx4 v[44:47], v14, s[60:63], s30 offen offset:1024 sc1
    s_add_u32 s30, s30, 2048
    s_sub_u32 s29, s29, 1
    s_cmp_eq_u32 s29, 0
    s_cbranch_scc1 P2_LY_done
    s_waitcnt vmcnt(20)
    v_mfma_f32_32x32x16_bf16 a[64:79], v[48:51], v[52:55], a[64:79]
    v_mfma_f32_32x32x16_bf16 a[80:95], v[48:51], v[60:63], a[80:95]
    buffer_load_dwordx4 v[48:51], v14, s[44:47], s30 offen offset:0 sc1
    v_mfma_f32_32x32x16_bf16 a[96:111], v[56:59], v[52:55], a[96:111]
    buffer_load_dwordx4 v[52:55], v14, s[48:51], s30 offen offset:0 sc1
    v_mfma_f32_32x32x16_bf16 a[112:127], v[56:59], v[60:63], a[112:127]
    buffer_load_dwordx4 v[56:59], v14, s[52:55], s30 offen offset:0 sc1
    buffer_load_dwordx4 v[60:63], v14, s[60:63], s30 offen offset:0 sc1
    s_waitcnt vmcnt(20)
    v_mfma_f32_32x32x16_bf16 a[64:79], v[64:67], v[68:71], a[64:79]
    v_mfma_f32_32x32x16_bf16 a[80:95], v[64:67], v[76:79], a[80:95]
    buffer_load_dwordx4 v[64:67], v14, s[44:47], s30 offen offset:1024 sc1
    v_mfma_f32_32x32x16_bf16 a[96:111], v[72:75], v[68:71], a[96:111]
    buffer_load_dwordx4 v[68:71], v14, s[48:51], s30 offen offset:1024 sc1
    v_mfma_f32_32x32x16_bf16 a[112:127], v[72:75], v[76:79], a[112:127]
    buffer_load_dwordx4 v[72:75], v14, s[52:55], s30 offen offset:1024 sc1
    buffer_load_dwordx4 v[76:79], v14, s[60:63], s30 offen offset:1024 sc1
    s_add_u32 s30, s30, 2048
    s_sub_u32 s29, s29, 1
    s_cmp_eq_u32 s29, 0
    s_cbranch_scc1 P2_LY_done
    s_waitcnt vmcnt(20)
    v_mfma_f32_32x32x16_bf16 a[64:79], v[80:83], v[84:87], a[64:79]
    v_mfma_f32_32x32x16_bf16 a[80:95], v[80:83], v[92:95], a[80:95]
    buffer_load_dwordx4 v[80:83], v14, s[44:47], s30 offen offset:0 sc1
    v_mfma_f32_32x32x16_bf16 a[96:111], v[88:91], v[84:87], a[96:111]
    buffer_load_dwordx4 v[84:87], v14, s[48:51], s30 offen offset:0 sc1
    v_mfma_f32_32x32x16_bf16 a[112:127], v[88:91], v[92:95], a[112:127]
    buffer_load_dwordx4 v[88:91], v14, s[52:55], s30 offen offset:0 sc1
    buffer_load_dwordx4 v[92:95], v14, s[60:63], s30 offen offset:0 sc1
    s_waitcnt vmcnt(20)
    v_mfma_f32_32x32x16_bf16 a[64:79], v[96:99], v[100:103], a[64:79]
    v_mfma_f32_32x32x16_bf16 a[80:95], v[96:99], v[108:111], a[80:95]
    buffer_load_dwordx4 v[96:99], v14, s[44:47], s30 offen offset:1024 sc1
    v_mfma_f32_32x32x16_bf16 a[96:111], v[104:107], v[100:103], a[96:111]
    buffer_load_dwordx4 v[100:103], v14, s[48:51], s30 offen offset:1024 sc1
    v_mfma_f32_32x32x16_bf16 a[112:127], v[104:107], v[108:111], a[112:127]
    buffer_load_dwordx4 v[104:107], v14, s[52:55], s30 offen offset:1024 sc1
    buffer_load_dwordx4 v[108:111], v14, s[60:63], s30 offen offset:1024 sc1
    s_add_u32 s30, s30, 2048
    s_sub_u32 s29, s29, 1
    s_cmp_lg_u32 s29, 0
    s_cbranch_scc1 P2_LY
P2_LY_done:
    s_cmp_lg_u32 s4, 0
    s_cbranch_scc1 P2_TN0
P2_T0:
    s_waitcnt vmcnt(20)
    v_mfma_f32_32x32x16_bf16 a[0:15], v[80:83], v[84:87], a[0:15]
    v_mfma_f32_32x32x16_bf16 a[32:47], v[88:91], v[84:87], a[32:47]
    v_mfma_f32_32x32x16_bf16 a[16:31], v[80:83], v[92:95], a[16:31]
    v_mfma_f32_32x32x16_bf16 a[48:63], v[88:91], v[92:95], a[48:63]
    s_waitcnt vmcnt(16)
    v_mfma_f32_32x32x16_bf16 a[0:15], v[96:99], v[100:103], a[0:15]
    v_mfma_f32_32x32x16_bf16 a[32:47], v[104:107], v[100:103], a[32:47]
    v_mfma_f32_32x32x16_bf16 a[16:31], v[96:99], v[108:111], a[16:31]
    v_mfma_f32_32x32x16_bf16 a[48:63], v[104:107], v[108:111], a[48:63]
    s_waitcnt vmcnt(12)
    v_mfma_f32_32x32x16_bf16 a[0:15], v[16:19], v[20:23], a[0:15]
    v_mfma_f32_32x32x16_bf16 a[32:47], v[24:27], v[20:23], a[32:47]
    v_mfma_f32_32x32x16_bf16 a[16:31], v[16:19], v[28:31], a[16:31]
    v_mfma_f32_32x32x16_bf16 a[48:63], v[24:27], v[28:31], a[48:63]
    s_waitcnt vmcnt(8)
    v_mfma_f32_32x32x16_bf16 a[0:15], v[32:35], v[36:39], a[0:15]
    v_mfma_f32_32x32x16_bf16 a[32:47], v[40:43], v[36:39], a[32:47]
    v_mfma_f32_32x32x16_bf16 a[16:31], v[32:35], v[44:47], a[16:31]
    v_mfma_f32_32x32x16_bf16 a[48:63], v[40:43], v[44:47], a[48:63]
    s_waitcnt vmcnt(4)
    v_mfma_f32_32x32x16_bf16 a[0:15], v[48:51], v[52:55], a[0:15]
    v_mfma_f32_32x32x16_bf16 a[32:47], v[56:59], v[52:55], a[32:47]
    v_mfma_f32_32x32x16_bf16 a[16:31], v[48:51], v[60:63], a[16:31]
    v_mfma_f32_32x32x16_bf16 a[48:63], v[56:59], v[60:63], a[48:63]
    s_waitcnt vmcnt(0)
    v_mfma_f32_32x32x16_bf16 a[0:15], v[64:67], v[68:71], a[0:15]
    v_mfma_f32_32x32x16_bf16 a[32:47], v[72:75], v[68:71], a[32:47]
    v_mfma_f32_32x32x16_bf16 a[16:31], v[64:67], v[76:79], a[16:31]
    v_mfma_f32_32x32x16_bf16 a[48:63], v[72:75], v[76:79], a[48:63]
    s_branch P2_TD
P2_TN0:
    s_cmp_lg_u32 s4, 1
    s_cbranch_scc1 P2_TN1
P2_T1:
    s_waitcnt vmcnt(20)
    v_mfma_f32_32x32x16_bf16 a[0:15], v[16:19], v[20:23], a[0:15]
    v_mfma_f32_32x32x16_bf16 a[32:47], v[24:27], v[20:23], a[32:47]
    v_mfma_f32_32x32x16_bf16 a[16:31], v[16:19], v[28:31], a[16:31]
    v_mfma_f32_32x32x16_bf16 a[48:63], v[24:27], v[28:31], a[48:63]
    s_waitcnt vmcnt(16)
    v_mfma_f32_32x32x16_bf16 a[0:15], v[32:35], v[36:39], a[0:15]
    v_mfma_f32_32x32x16_bf16 a[32:47], v[40:43], v[36:39], a[32:47]
    v_mfma_f32_32x32x16_bf16 a[16:31], v[32:35], v[44:47], a[16:31]
    v_mfma_f32_32x32x16_bf16 a[48:63], v[40:43], v[44:47], a[48:63]
    s_waitcnt vmcnt(12)
    v_mfma_f32_32x32x16_bf16 a[0:15], v[48:51], v[52:55], a[0:15]
    v_mfma_f32_32x32x16_bf16 a[32:47], v[56:59], v[52:55], a[32:47]
    v_mfma_f32_32x32x16_bf16 a[16:31], v[48:51], v[60:63], a[16:31]
    v_mfma_f32_32x32x16_bf16 a[48:63], v[56:59], v[60:63], a[48:63]
    s_waitcnt vmcnt(8)
    v_mfma_f32_32x32x16_bf16 a[0:15], v[64:67], v[68:71], a[0:15]
    v_mfma_f32_32x32x16_bf16 a[32:47], v[72:75], v[68:71], a[32:47]
    v_mfma_f32_32x32x16_bf16 a[16:31], v[64:67], v[76:79], a[16:31]
    v_mfma_f32_32x32x16_bf16 a[48:63], v[72:75], v[76:79], a[48:63]
    s_waitcnt vmcnt(4)
    v_mfma_f32_32x32x16_bf16 a[0:15], v[80:83], v[84:87], a[0:15]
    v_mfma_f32_32x32x16_bf16 a[32:47], v[88:91], v[84:87], a[32:47]
    v_mfma_f32_32x32x16_bf16 a[16:31], v[80:83], v[92:95], a[16:31]
    v_mfma_f32_32x32x16_bf16 a[48:63], v[88:91], v[92:95], a[48:63]
    s_waitcnt vmcnt(0)
    v_mfma_f32_32x32x16_bf16 a[0:15], v[96:99], v[100:103], a[0:15]
    v_mfma_f32_32x32x16_bf16 a[32:47], v[104:107], v[100:103], a[32:47]
    v_mfma_f32_32x32x16_bf16 a[16:31], v[96:99], v[108:111], a[16:31]
    v_mfma_f32_32x32x16_bf16 a[48:63], v[104:107], v[108:111], a[48:63]
    s_branch P2_TD
P2_TN1:
    s_cmp_lg_u32 s4, 2
    s_cbranch_scc1 P2_TN2
P2_T2:
    s_waitcnt vmcnt(20)
    v_mfma_f32_32x32x16_bf16 a[64:79], v[16:19], v[20:23], a[64:79]
    v_mfma_f32_32x32x16_bf16 a[96:111], v[24:27], v[20:23], a[96:111]
    v_mfma_f32_32x32x16_bf16 a[80:95], v[16:19], v[28:31], a[80:95]
    v_mfma_f32_32x32x16_bf16 a[112:127], v[24:27], v[28:31], a[112:127]
    s_waitcnt vmcnt(16)
    v_mfma_f32_32x32x16_bf16 a[64:79], v[32:35], v[36:39], a[64:79]
    v_mfma_f32_32x32x16_bf16 a[96:111], v[40:43], v[36:39], a[96:111]
    v_mfma_f32_32x32x16_bf16 a[80:95], v[32:35], v[44:47], a[80:95]
    v_mfma_f32_32x32x16_bf16 a[112:127], v[40:43], v[44:47], a[112:127]
    s_waitcnt vmcnt(12)
    v_mfma_f32_32x32x16_bf16 a[64:79], v[48:51], v[52:55], a[64:79]
    v_mfma_f32_32x32x16_bf16 a[96:111], v[56:59], v[52:55], a[96:111]
    v_mfma_f32_32x32x16_bf16 a[80:95], v[48:51], v[60:63], a[80:95]
    v_mfma_f32_32x32x16_bf16 a[112:127], v[56:59], v[60:63], a[112:127]
    s_waitcnt vmcnt(8)
    v_mfma_f32_32x32x16_bf16 a[64:79], v[64:67], v[68:71], a[64:79]
    v_mfma_f32_32x32x16_bf16 a[96:111], v[72:75], v[68:71], a[96:111]
    v_mfma_f32_32x32x16_bf16 a[80:95], v[64:67], v[76:79], a[80:95]
    v_mfma_f32_32x32x16_bf16 a[112:127], v[72:75], v[76:79], a[112:127]
    s_waitcnt vmcnt(4)
    v_mfma_f32_32x32x16_bf16 a[64:79], v[80:83], v[84:87], a[64:79]
    v_mfma_f32_32x32x16_bf16 a[96:111], v[88:91], v[84:87], a[96:111]
    v_mfma_f32_32x32x16_bf16 a[80:95], v[80:83], v[92:95], a[80:95]
    v_mfma_f32_32x32x16_bf16 a[112:127], v[88:91], v[92:95], a[112:127]
    s_waitcnt vmcnt(0)
    v_mfma_f32_32x32x16_bf16 a[64:79], v[96:99], v[100:103], a[64:79]
    v_mfma_f32_32x32x16_bf16 a[96:111], v[104:107], v[100:103], a[96:111]
    v_mfma_f32_32x32x16_bf16 a[80:95], v[96:99], v[108:111], a[80:95]
    v_mfma_f32_32x32x16_bf16 a[112:127], v[104:107], v[108:111], a[112:127]
    s_branch P2_TD
P2_TN2:
    s_waitcnt vmcnt(20)
    v_mfma_f32_32x32x16_bf16 a[64:79], v[80:83], v[84:87], a[64:79]
    v_mfma_f32_32x32x16_bf16 a[96:111], v[88:91], v[84:87], a[96:111]
    v_mfma_f32_32x32x16_bf16 a[80:95], v[80:83], v[92:95], a[80:95]
    v_mfma_f32_32x32x16_bf16 a[112:127], v[88:91], v[92:95], a[112:127]
    s_waitcnt vmcnt(16)
    v_mfma_f32_32x32x16_bf16 a[64:79], v[96:99], v[100:103], a[64:79]
    v_mfma_f32_32x32x16_bf16 a[96:111], v[104:107], v[100:103], a[96:111]
    v_mfma_f32_32x32x16_bf16 a[80:95], v[96:99], v[108:111], a[80:95]
    v_mfma_f32_32x32x16_bf16 a[112:127], v[104:107], v[108:111], a[112:127]
    s_waitcnt vmcnt(12)
    v_mfma_f32_32x32x16_bf16 a[64:79], v[16:19], v[20:23], a[64:79]
    v_mfma_f32_32x32x16_bf16 a[96:111], v[24:27], v[20:23], a[96:111]
    v_mfma_f32_32x32x16_bf16 a[80:95], v[16:19], v[28:31], a[80:95]
    v_mfma_f32_32x32x16_bf16 a[112:127], v[24:27], v[28:31], a[112:127]
    s_waitcnt vmcnt(8)
    v_mfma_f32_32x32x16_bf16 a[64:79], v[32:35], v[36:39], a[64:79]
    v_mfma_f32_32x32x16_bf16 a[96:111], v[40:43], v[36:39], a[96:111]
    v_mfma_f32_32x32x16_bf16 a[80:95], v[32:35], v[44:47], a[80:95]
    v_mfma_f32_32x32x16_bf16 a[112:127], v[40:43], v[44:47], a[112:127]
    s_waitcnt vmcnt(4)
    v_mfma_f32_32x32x16_bf16 a[64:79], v[48:51], v[52:55], a[64:79]
    v_mfma_f32_32x32x16_bf16 a[96:111], v[56:59], v[52:55], a[96:111]
    v_mfma_f32_32x32x16_bf16 a[80:95], v[48:51], v[60:63], a[80:95]
    v_mfma_f32_32x32x16_bf16 a[112:127], v[56:59], v[60:63], a[112:127]
    s_waitcnt vmcnt(0)
    v_mfma_f32_32x32x16_bf16 a[64:79], v[64:67], v[68:71], a[64:79]
    v_mfma_f32_32x32x16_bf16 a[96:111], v[72:75], v[68:71], a[96:111]
    v_mfma_f32_32x32x16_bf16 a[80:95], v[64:67], v[76:79], a[80:95]
    v_mfma_f32_32x32x16_bf16 a[112:127], v[72:75], v[76:79], a[112:127]
P2_TD:
    v_and_b32 v13, 31, v0
    v_lshrrev_b32 v15, 5, v0
    v_mul_u32_u24 v13, 272, v13
    v_lshl_add_u32 v13, v15, 4, v13
    s_mul_i32 s26, s4, 17408
    v_add_u32 v13, s26, v13
    s_nop 7
    s_cmp_ge_u32 s4, 2
    s_cbranch_scc1 P2_NOB
    ds_write_b128 v13, a[0:3] offset:0
    ds_write_b128 v13, a[4:7] offset:32
    ds_write_b128 v13, a[8:11] offset:64
    ds_write_b128 v13, a[12:15] offset:96
    ds_write_b128 v13, a[16:19] offset:8704
    ds_write_b128 v13, a[20:23] offset:8736
    ds_write_b128 v13, a[24:27] offset:8768
    ds_write_b128 v13, a[28:31] offset:8800
    ds_write_b128 v13, a[32:35] offset:128
    ds_write_b128 v13, a[36:39] offset:160
    ds_write_b128 v13, a[40:43] offset:192
    ds_write_b128 v13, a[44:47] offset:224
    ds_write_b128 v13, a[48:51] offset:8832
    ds_write_b128 v13, a[52:55] offset:8864
    ds_write_b128 v13, a[56:59] offset:8896
    ds_write_b128 v13, a[60:63] offset:8928
P2_NOB:
    s_cmp_lt_u32 s4, 2
    s_cbranch_scc1 P2_NOY
    v_add_u32 v13, 17408, v13
    ds_write_b128 v13, a[64:67] offset:0
    ds_write_b128 v13, a[68:71] offset:32
    ds_write_b128 v13, a[72:75] offset:64
    ds_write_b128 v13, a[76:79] offset:96
    ds_write_b128 v13, a[80:83] offset:8704
    ds_write_b128 v13, a[84:87] offset:8736
    ds_write_b128 v13, a[88:91] offset:8768
    ds_write_b128 v13, a[92:95] offset:8800
    ds_write_b128 v13, a[96:99] offset:128
    ds_write_b128 v13, a[100:103] offset:160
    ds_write_b128 v13, a[104:107] offset:192
    ds_write_b128 v13, a[108:111] offset:224
    ds_write_b128 v13, a[112:115] offset:8832
    ds_write_b128 v13, a[116:119] offset:8864
    ds_write_b128 v13, a[120:123] offset:8896
    ds_write_b128 v13, a[124:127] offset:8928
P2_NOY:
    s_lshl_b32 s26, s4, 6
    v_add_u32 v10, s26, v0
    v_lshrrev_b32 v11, 4, v10
    v_and_b32 v10, 15, v10
    v_mul_u32_u24 v11, 272, v11
    v_lshl_add_u32 v11, v10, 4, v11
    v_add_u32 v10, 34816, v11
    s_mov_b32 s24, 2.0
    s_mov_b32 s25, 2.0
    s_waitcnt vmcnt(0) lgkmcnt(0)
    s_barrier
    ds_read_b128 v[16:19], v11 offset:0
    ds_read_b128 v[20:23], v11 offset:17408
    ds_read_b128 v[24:27], v10 offset:0
    ds_read_b128 v[28:31], v10 offset:17408
    ds_read_b128 v[32:35], v10 offset:34816
    ds_read_b128 v[36:39], v11 offset:4352
    ds_read_b128 v[40:43], v11 offset:21760
    ds_read_b128 v[44:47], v10 offset:4352
    ds_read_b128 v[48:51], v10 offset:21760
    ds_read_b128 v[52:55], v10 offset:39168
    s_waitcnt lgkmcnt(5)
    v_pk_add_f32 v[16:17], v[16:17], v[20:21]
    v_pk_add_f32 v[28:29], v[28:29], v[32:33]
    v_pk_add_f32 v[18:19], v[18:19], v[22:23]
    v_pk_add_f32 v[30:31], v[30:31], v[34:35]
    v_pk_add_f32 v[16:17], v[16:17], v[24:25]
    v_pk_fma_f32 v[28:29], v[0:1], v[28:29], v[112:113] op_sel:[1,0,0] op_sel_hi:[1,1,1]
    v_pk_add_f32 v[18:19], v[18:19], v[26:27]
    v_pk_fma_f32 v[30:31], v[0:1], v[30:31], v[114:115] op_sel:[1,0,0] op_sel_hi:[1,1,1]
    v_cvt_pk_bf16_f32 v13, v16, v17
    v_cvt_pk_bf16_f32 v15, v18, v19
    v_lshlrev_b32 v16, 16, v13
    v_and_b32 v17, 0xffff0000, v13
    v_lshlrev_b32 v18, 16, v15
    v_and_b32 v19, 0xffff0000, v15
    v_pk_mul_f32 v[16:17], v[4:5], v[16:17] op_sel:[1,0] op_sel_hi:[1,1]
    v_pk_mul_f32 v[18:19], v[4:5], v[18:19] op_sel:[1,0] op_sel_hi:[1,1]
    v_cvt_pk_bf16_f32 v13, v16, v17
    v_cvt_pk_bf16_f32 v15, v18, v19
    v_lshlrev_b32 v16, 16, v13
    v_and_b32 v17, 0xffff0000, v13
    v_lshlrev_b32 v18, 16, v15
    v_and_b32 v19, 0xffff0000, v15
    v_pk_add_f32 v[16:17], v[16:17], v[28:29]
    v_pk_add_f32 v[18:19], v[18:19], v[30:31]
    s_mov_b32 s26, 0
    buffer_store_dwordx4 v[16:19], v9, s[72:75], s26 offen sc1
    s_waitcnt lgkmcnt(0)
    v_pk_add_f32 v[36:37], v[36:37], v[40:41]
    v_pk_add_f32 v[48:49], v[48:49], v[52:53]
    v_pk_add_f32 v[38:39], v[38:39], v[42:43]
    v_pk_add_f32 v[50:51], v[50:51], v[54:55]
    v_pk_add_f32 v[36:37], v[36:37], v[44:45]
    v_pk_fma_f32 v[48:49], v[2:3], v[48:49], v[116:117] op_sel:[0,0,0] op_sel_hi:[0,1,1]
    v_pk_add_f32 v[38:39], v[38:39], v[46:47]
    v_pk_fma_f32 v[50:51], v[2:3], v[50:51], v[118:119] op_sel:[0,0,0] op_sel_hi:[0,1,1]
    v_cvt_pk_bf16_f32 v13, v36, v37
    v_cvt_pk_bf16_f32 v15, v38, v39
    v_lshlrev_b32 v36, 16, v13
    v_and_b32 v37, 0xffff0000, v13
    v_lshlrev_b32 v38, 16, v15
    v_and_b32 v39, 0xffff0000, v15
    v_pk_mul_f32 v[36:37], v[6:7], v[36:37] op_sel:[0,0] op_sel_hi:[0,1]
    v_pk_mul_f32 v[38:39], v[6:7], v[38:39] op_sel:[0,0] op_sel_hi:[0,1]
    v_cvt_pk_bf16_f32 v13, v36, v37
    v_cvt_pk_bf16_f32 v15, v38, v39
    v_lshlrev_b32 v36, 16, v13
    v_and_b32 v37, 0xffff0000, v13
    v_lshlrev_b32 v38, 16, v15
    v_and_b32 v39, 0xffff0000, v15
    v_pk_add_f32 v[36:37], v[36:37], v[48:49]
    v_pk_add_f32 v[38:39], v[38:39], v[50:51]
    s_mov_b32 s26, 8192
    buffer_store_dwordx4 v[36:39], v9, s[72:75], s26 offen sc1
    s_endpgm
KB_EQ:
    v_lshrrev_b32 v12, 4, v0
    v_and_b32 v13, 15, v0
    v_xor_b32 v13, v13, v12
    v_lshlrev_b32 v13, 4, v13
    v_lshl_add_u32 v5, v12, 10, v13
    v_and_b32 v15, 1, v12
    v_lshrrev_b32 v12, 1, v12
    v_lshl_add_u32 v12, v15, 3, v12
    v_lshl_add_u32 v1, v12, 10, v13
    v_xor_b32 v2, 64, v1
    v_add_u32 v2, 15360, v2
    v_xor_b32 v3, 128, v1
    v_xor_b32 v4, 192, v1
    v_add_u32 v4, 15360, v4
    s_lshl_b32 s10, s5, 2
    s_add_u32 s10, s10, s4
    s_lshl_b32 s10, s10, 15
    s_lshl_b32 s79, s4, 13
    s_lshl_b32 s9, s4, 12
    s_waitcnt lgkmcnt(0)
    s_mov_b32 s44, s16
    s_and_b32 s45, s17, 0xffff
    s_mov_b32 s46, 2097152
    s_mov_b32 s47, 0x20000
    s_add_u32 m0, s79, 0
    s_add_u32 s77, s10, 0
    buffer_load_dwordx4 v1, s[44:47], s77 offen offset:0 lds
    buffer_load_dwordx4 v2, s[44:47], s77 offen offset:1024 lds
    buffer_load_dwordx4 v3, s[44:47], s77 offen offset:2048 lds
    buffer_load_dwordx4 v4, s[44:47], s77 offen offset:3072 lds
    s_add_u32 m0, s79, 4096
    s_add_u32 s77, s10, 4096
    buffer_load_dwordx4 v1, s[44:47], s77 offen offset:0 lds
    buffer_load_dwordx4 v2, s[44:47], s77 offen offset:1024 lds
    buffer_load_dwordx4 v3, s[44:47], s77 offen offset:2048 lds
    buffer_load_dwordx4 v4, s[44:47], s77 offen offset:3072 lds
    v_xor_b32 v6, 64, v5
    v_add_u32 v6, 3072, v6
    v_xor_b32 v7, 128, v5
    v_add_u32 v7, 6144, v7
    v_xor_b32 v96, 192, v5
    v_add_u32 v96, 9216, v96
    s_lshl_b32 s11, s6, 1
    s_and_b32 s76, s4, 1
    s_add_u32 s11, s11, s76
    s_lshl_b32 s11, s11, 14
    s_cmp_lt_u32 s4, 2
    s_cselect_b32 s48, s22, s24
    s_cselect_b32 s49, s23, s25
    s_and_b32 s49, s49, 0xffff
    s_mov_b32 s50, 524288
    s_mov_b32 s51, 0x20000
    s_add_u32 m0, s9, 32768
    s_add_u32 s77, s11, 0
    buffer_load_dwordx4 v5, s[48:51], s77 offen offset:0 lds
    buffer_load_dwordx4 v6, s[48:51], s77 offen offset:1024 lds
    buffer_load_dwordx4 v7, s[48:51], s77 offen offset:2048 lds
    buffer_load_dwordx4 v96, s[48:51], s77 offen offset:3072 lds
    s_add_u32 m0, s79, 49152
    s_add_u32 s77, s10, 256
    buffer_load_dwordx4 v1, s[44:47], s77 offen offset:0 lds
    buffer_load_dwordx4 v2, s[44:47], s77 offen offset:1024 lds
    buffer_load_dwordx4 v3, s[44:47], s77 offen offset:2048 lds
    buffer_load_dwordx4 v4, s[44:47], s77 offen offset:3072 lds
    s_add_u32 m0, s79, 53248
    s_add_u32 s77, s10, 4352
    buffer_load_dwordx4 v1, s[44:47], s77 offen offset:0 lds
    buffer_load_dwordx4 v2, s[44:47], s77 offen offset:1024 lds
    buffer_load_dwordx4 v3, s[44:47], s77 offen offset:2048 lds
    buffer_load_dwordx4 v4, s[44:47], s77 offen offset:3072 lds
    s_add_u32 m0, s9, 81920
    s_add_u32 s77, s11, 256
    buffer_load_dwordx4 v5, s[48:51], s77 offen offset:0 lds
    buffer_load_dwordx4 v6, s[48:51], s77 offen offset:1024 lds
    buffer_load_dwordx4 v7, s[48:51], s77 offen offset:2048 lds
    buffer_load_dwordx4 v96, s[48:51], s77 offen offset:3072 lds
    v_lshrrev_b32 v12, 3, v0
    v_mul_u32_u24 v97, 3584, v12
    v_lshlrev_b32 v98, 10, v12
    v_bfe_u32 v12, v0, 4, 1
    v_lshlrev_b32 v12, 2, v12
    v_and_b32 v13, 7, v0
    v_xor_b32 v13, v13, v12
    v_lshl_add_u32 v97, v13, 4, v97
    v_lshl_add_u32 v98, v13, 4, v98
    s_mul_i32 s12, s4, 114688
    s_add_u32 s12, s12, s7
    s_mov_b32 s52, s32
    s_and_b32 s53, s33, 0xffff
    s_mov_b32 s54, 1835008
    s_mov_b32 s55, 0x20000
    v_and_b32 v12, 31, v0
    v_lshrrev_b32 v13, 5, v0
    v_and_b32 v15, 15, v0
    v_xor_b32 v13, v13, v15
    v_lshlrev_b32 v13, 4, v13
    v_lshl_add_u32 v9, v12, 8, v13
    s_lshl_b32 s76, s4, 13
    v_add_u32 v8, s76, v9
    v_lshrrev_b32 v12, 5, v0
    v_lshlrev_b32 v12, 3, v12
    v_bfe_u32 v13, v0, 2, 2
    v_add_u32 v12, v12, v13
    v_lshlrev_b32 v12, 7, v12
    v_bfe_u32 v13, v0, 3, 1
    v_lshl_add_u32 v12, v13, 6, v12
    v_bfe_u32 v13, v0, 4, 1
    v_lshl_add_u32 v12, v13, 5, v12
    v_and_b32 v13, 3, v0
    v_lshl_add_u32 v10, v13, 3, v12
    v_xor_b32 v11, 64, v10
    v_lshlrev_b32 v14, 4, v0
    s_mov_b32 s56, s42
    s_and_b32 s57, s43, 0xffff
    s_mov_b32 s58, 14655488
    s_mov_b32 s59, 0x20000
    s_lshl_b32 s80, s5, 2
    s_add_u32 s80, s80, s4
    s_mul_i32 s80, s80, 180224
    s_lshl_b32 s76, s5, 7
    s_lshl_b32 s77, s6, 3
    s_add_u32 s76, s76, s77
    s_lshl_b32 s77, s4, 1
    s_add_u32 s21, s76, s77
    s_lshl_b32 s76, s21, 10
    buffer_load_dwordx4 v[48:51], v14, s[44:47], s76 offen
    buffer_load_dwordx4 v[52:55], v14, s[44:47], s76 offen offset:1024
    s_mov_b32 s64, s36
    s_and_b32 s65, s37, 0xffff
    s_mov_b32 s66, 1024
    s_mov_b32 s67, 0x20000
    buffer_load_dwordx4 v[56:59], v14, s[64:67], 0 offen
    s_waitcnt vmcnt(15) lgkmcnt(0)
    s_barrier
    v_add_u32 v15, 0, v8
    ds_read_b128 a[0:3], v15
    v_xor_b32 v12, 32, v15
    ds_read_b128 a[4:7], v12
    v_xor_b32 v12, 64, v15
    ds_read_b128 a[8:11], v12
    v_xor_b32 v12, 96, v15
    ds_read_b128 a[12:15], v12
    v_xor_b32 v12, 128, v15
    ds_read_b128 a[16:19], v12
    v_xor_b32 v12, 160, v15
    ds_read_b128 a[20:23], v12
    v_xor_b32 v12, 192, v15
    ds_read_b128 a[24:27], v12
    v_xor_b32 v12, 224, v15
    ds_read_b128 a[28:31], v12
    s_add_u32 m0, s79, 98304
    s_add_u32 s77, s10, 512
    buffer_load_dwordx4 v1, s[44:47], s77 offen offset:0 lds
    buffer_load_dwordx4 v2, s[44:47], s77 offen offset:1024 lds
    buffer_load_dwordx4 v3, s[44:47], s77 offen offset:2048 lds
    buffer_load_dwordx4 v4, s[44:47], s77 offen offset:3072 lds
    s_add_u32 m0, s79, 102400
    s_add_u32 s77, s10, 4608
    buffer_load_dwordx4 v1, s[44:47], s77 offen offset:0 lds
    buffer_load_dwordx4 v2, s[44:47], s77 offen offset:1024 lds
    buffer_load_dwordx4 v3, s[44:47], s77 offen offset:2048 lds
    buffer_load_dwordx4 v4, s[44:47], s77 offen offset:3072 lds
    s_add_u32 m0, s9, 131072
    s_add_u32 s77, s11, 512
    buffer_load_dwordx4 v5, s[48:51], s77 offen offset:0 lds
    buffer_load_dwordx4 v6, s[48:51], s77 offen offset:1024 lds
    buffer_load_dwordx4 v7, s[48:51], s77 offen offset:2048 lds
    buffer_load_dwordx4 v96, s[48:51], s77 offen offset:3072 lds
    s_mov_b32 s64, s34
    s_and_b32 s65, s35, 0xffff
    s_mov_b32 s66, 1835008
    s_mov_b32 s67, 0x20000
    s_lshr_b32 s76, s13, 5
    s_cmp_eq_u32 s76, 0
    s_cselect_b32 s68, s26, s28
    s_cselect_b32 s69, s27, s29
    s_and_b32 s69, s69, 0xffff
    s_mov_b32 s70, 524288
    s_mov_b32 s71, 0x20000
    s_mov_b32 s16, 0xbfb8aa3b
    s_mov_b32 s17, 0xbfb8aa3b
    s_mov_b32 s18, 1.0
    s_mov_b32 s19, 1.0
    s_mov_b32 s20, 0xffff0000
    s_waitcnt vmcnt(15) lgkmcnt(0)
    s_barrier
    v_add_u32 v15, 49152, v8
    ds_read_b128 a[32:35], v15
    v_xor_b32 v12, 32, v15
    ds_read_b128 a[36:39], v12
    v_xor_b32 v12, 64, v15
    ds_read_b128 a[40:43], v12
    v_xor_b32 v12, 96, v15
    ds_read_b128 a[44:47], v12
    v_xor_b32 v12, 128, v15
    ds_read_b128 a[48:51], v12
    v_xor_b32 v12, 160, v15
    ds_read_b128 a[52:55], v12
    v_xor_b32 v12, 192, v15
    ds_read_b128 a[56:59], v12
    v_xor_b32 v12, 224, v15
    ds_read_b128 a[60:63], v12
    s_add_u32 m0, s79, 0
    s_add_u32 s77, s10, 768
    buffer_load_dwordx4 v1, s[44:47], s77 offen offset:0 lds
    buffer_load_dwordx4 v2, s[44:47], s77 offen offset:1024 lds
    buffer_load_dwordx4 v3, s[44:47], s77 offen offset:2048 lds
    buffer_load_dwordx4 v4, s[44:47], s77 offen offset:3072 lds
    s_add_u32 m0, s79, 4096
    s_add_u32 s77, s10, 4864
    buffer_load_dwordx4 v1, s[44:47], s77 offen offset:0 lds
    buffer_load_dwordx4 v2, s[44:47], s77 offen offset:1024 lds
    buffer_load_dwordx4 v3, s[44:47], s77 offen offset:2048 lds
    buffer_load_dwordx4 v4, s[44:47], s77 offen offset:3072 lds
    s_add_u32 m0, s9, 32768
    s_add_u32 s77, s11, 768
    buffer_load_dwordx4 v5, s[48:51], s77 offen offset:0 lds
    buffer_load_dwordx4 v6, s[48:51], s77 offen offset:1024 lds
    buffer_load_dwordx4 v7, s[48:51], s77 offen offset:2048 lds
    buffer_load_dwordx4 v96, s[48:51], s77 offen offset:3072 lds
    s_lshr_b32 s77, s13, 3
    s_mul_i32 s14, s77, 229376
    s_and_b32 s78, s13, 7
    s_lshl_b32 s78, s78, 7
    s_add_u32 s14, s14, s78
    s_lshl_b32 s78, s4, 16
    s_add_u32 s14, s14, s78
    s_lshr_b32 s77, s13, 1
    s_and_b32 s77, s77, 15
    s_lshl_b32 s15, s77, 15
    s_and_b32 s78, s13, 1
    s_lshl_b32 s78, s78, 9
    s_add_u32 s15, s15, s78
    s_lshl_b32 s78, s4, 13
    s_add_u32 s15, s15, s78
    v_lshrrev_b32 v13, 5, v0
    v_and_b32 v12, 31, v0
    v_xor_b32 v12, v12, v13
    s_and_b32 s78, s4, 1
    s_lshl_b32 s78, s78, 3
    v_xor_b32 v12, s78, v12
    v_lshlrev_b32 v12, 4, v12
    v_lshl_add_u32 v99, v13, 10, v12
    s_waitcnt vmcnt(12) lgkmcnt(0)
    s_barrier
    v_add_u32 v15, 98304, v8
    ds_read_b128 a[64:67], v15
    v_xor_b32 v12, 32, v15
    ds_read_b128 a[68:71], v12
    v_xor_b32 v12, 64, v15
    ds_read_b128 a[72:75], v12
    v_xor_b32 v12, 96, v15
    ds_read_b128 a[76:79], v12
    v_xor_b32 v12, 128, v15
    ds_read_b128 a[80:83], v12
    v_xor_b32 v12, 160, v15
    ds_read_b128 a[84:87], v12
    v_xor_b32 v12, 192, v15
    ds_read_b128 a[88:91], v12
    v_xor_b32 v12, 224, v15
    ds_read_b128 a[92:95], v12
    s_add_u32 m0, s9, 147456
    s_add_u32 s77, s12, 0
    buffer_load_dwordx4 v97, s[52:55], s77 offen offset:0 lds
    v_mov_b32 v120, 0
    v_lshlrev_b32 v116, 16, v48
    v_and_b32 v117, 0xffff0000, v48
    v_lshlrev_b32 v118, 16, v56
    v_and_b32 v119, 0xffff0000, v56
    v_mul_f32 v116, v116, v118
    v_mul_f32 v117, v117, v119
    v_cvt_pk_bf16_f32 v116, v116, v117
    s_add_u32 s77, s77, 27648
    buffer_load_dwordx4 v97, s[52:55], s77 offen offset:1024 lds
    v_lshlrev_b32 v117, 16, v116
    v_and_b32 v116, 0xffff0000, v116
    v_add_f32 v120, v120, v117
    v_add_f32 v120, v120, v116
    v_lshlrev_b32 v116, 16, v49
    v_and_b32 v117, 0xffff0000, v49
    v_lshlrev_b32 v118, 16, v57
    v_and_b32 v119, 0xffff0000, v57
    s_add_u32 s77, s77, 27648
    buffer_load_dwordx4 v97, s[52:55], s77 offen offset:2048 lds
    v_mul_f32 v116, v116, v118
    v_mul_f32 v117, v117, v119
    v_cvt_pk_bf16_f32 v116, v116, v117
    v_lshlrev_b32 v117, 16, v116
    v_and_b32 v116, 0xffff0000, v116
    v_add_f32 v120, v120, v117
    v_add_f32 v120, v120, v116
    v_lshlrev_b32 v116, 16, v50
    s_add_u32 s77, s77, 27648
    buffer_load_dwordx4 v97, s[52:55], s77 offen offset:3072 lds
    v_and_b32 v117, 0xffff0000, v50
    v_lshlrev_b32 v118, 16, v58
    v_and_b32 v119, 0xffff0000, v58
    v_mul_f32 v116, v116, v118
    v_mul_f32 v117, v117, v119
    v_cvt_pk_bf16_f32 v116, v116, v117
    v_lshlrev_b32 v117, 16, v116
    v_and_b32 v116, 0xffff0000, v116
    s_add_u32 m0, s9, 49152
    s_add_u32 s77, s12, 458752
    buffer_load_dwordx4 v97, s[52:55], s77 offen offset:0 lds
    v_add_f32 v120, v120, v117
    v_add_f32 v120, v120, v116
    v_lshlrev_b32 v116, 16, v51
    v_and_b32 v117, 0xffff0000, v51
    v_lshlrev_b32 v118, 16, v59
    v_and_b32 v119, 0xffff0000, v59
    v_mul_f32 v116, v116, v118
    v_mul_f32 v117, v117, v119
    s_add_u32 s77, s77, 27648
    buffer_load_dwordx4 v97, s[52:55], s77 offen offset:1024 lds
    v_cvt_pk_bf16_f32 v116, v116, v117
    v_lshlrev_b32 v117, 16, v116
    v_and_b32 v116, 0xffff0000, v116
    v_add_f32 v120, v120, v117
    v_add_f32 v120, v120, v116
    v_mov_b32 v121, 0
    v_lshlrev_b32 v116, 16, v52
    s_add_u32 s77, s77, 27648
    buffer_load_dwordx4 v97, s[52:55], s77 offen offset:2048 lds
    v_and_b32 v117, 0xffff0000, v52
    v_lshlrev_b32 v118, 16, v56
    v_and_b32 v119, 0xffff0000, v56
    v_mul_f32 v116, v116, v118
    v_mul_f32 v117, v117, v119
    v_cvt_pk_bf16_f32 v116, v116, v117
    v_lshlrev_b32 v117, 16, v116
    v_and_b32 v116, 0xffff0000, v116
    s_add_u32 s77, s77, 27648
    buffer_load_dwordx4 v97, s[52:55], s77 offen offset:3072 lds
    v_add_f32 v121, v121, v117
    v_add_f32 v121, v121, v116
    v_lshlrev_b32 v116, 16, v53
    v_and_b32 v117, 0xffff0000, v53
    v_lshlrev_b32 v118, 16, v57
    v_and_b32 v119, 0xffff0000, v57
    v_mul_f32 v116, v116, v118
    v_mul_f32 v117, v117, v119
    s_add_u32 m0, s9, 65536
    s_add_u32 s77, s12, 917504
    buffer_load_dwordx4 v97, s[52:55], s77 offen offset:0 lds
    v_cvt_pk_bf16_f32 v116, v116, v117
    v_lshlrev_b32 v117, 16, v116
    v_and_b32 v116, 0xffff0000, v116
    v_add_f32 v121, v121, v117
    v_add_f32 v121, v121, v116
    v_lshlrev_b32 v116, 16, v54
    v_and_b32 v117, 0xffff0000, v54
    v_lshlrev_b32 v118, 16, v58
    s_add_u32 s77, s77, 27648
    buffer_load_dwordx4 v97, s[52:55], s77 offen offset:1024 lds
    v_and_b32 v119, 0xffff0000, v58
    v_mul_f32 v116, v116, v118
    v_mul_f32 v117, v117, v119
    v_cvt_pk_bf16_f32 v116, v116, v117
    v_lshlrev_b32 v117, 16, v116
    v_and_b32 v116, 0xffff0000, v116
    v_add_f32 v121, v121, v117
    v_add_f32 v121, v121, v116
    s_add_u32 s77, s77, 27648
    buffer_load_dwordx4 v97, s[52:55], s77 offen offset:2048 lds
    v_lshlrev_b32 v116, 16, v55
    v_and_b32 v117, 0xffff0000, v55
    v_lshlrev_b32 v118, 16, v59
    v_and_b32 v119, 0xffff0000, v59
    v_mul_f32 v116, v116, v118
    v_mul_f32 v117, v117, v119
    v_cvt_pk_bf16_f32 v116, v116, v117
    s_add_u32 s77, s77, 27648
    buffer_load_dwordx4 v97, s[52:55], s77 offen offset:3072 lds
    v_lshlrev_b32 v117, 16, v116
    v_and_b32 v116, 0xffff0000, v116
    v_add_f32 v121, v121, v117
    v_add_f32 v121, v121, v116
    s_nop 0
    v_add_f32_dpp v120, v120, v120 row_shr:1 bound_ctrl:0
    v_add_f32_dpp v121, v121, v121 row_shr:1 bound_ctrl:0
    s_nop 0
    s_add_u32 m0, s9, 81920
    s_add_u32 s77, s12, 1376256
    buffer_load_dwordx4 v97, s[52:55], s77 offen offset:0 lds
    v_add_f32_dpp v120, v120, v120 row_shr:2 bound_ctrl:0
    v_add_f32_dpp v121, v121, v121 row_shr:2 bound_ctrl:0
    s_nop 0
    v_add_f32_dpp v120, v120, v120 row_shr:4 bound_ctrl:0
    v_add_f32_dpp v121, v121, v121 row_shr:4 bound_ctrl:0
    s_nop 0
    v_add_f32_dpp v120, v120, v120 row_shr:8 bound_ctrl:0
    v_add_f32_dpp v121, v121, v121 row_shr:8 bound_ctrl:0
    s_add_u32 s77, s77, 27648
    buffer_load_dwordx4 v97, s[52:55], s77 offen offset:1024 lds
    s_nop 0
    v_add_f32_dpp v120, v120, v120 row_bcast:15 row_mask:0xa
    v_add_f32_dpp v121, v121, v121 row_bcast:15 row_mask:0xa
    s_nop 0
    v_add_f32_dpp v120, v120, v120 row_bcast:31 row_mask:0xc
    v_add_f32_dpp v121, v121, v121 row_bcast:31 row_mask:0xc
    v_cvt_pk_bf16_f32 v120, v120, v120
    v_and_b32 v120, 0xffff0000, v120
    s_add_u32 s77, s77, 27648
    buffer_load_dwordx4 v97, s[52:55], s77 offen offset:2048 lds
    v_mul_f32 v120, 0xbfb8aa3b, v120
    v_cvt_pk_bf16_f32 v121, v121, v121
    v_and_b32 v121, 0xffff0000, v121
    v_mul_f32 v121, 0xbfb8aa3b, v121
    v_exp_f32 v120, v120
    v_exp_f32 v121, v121
    s_nop 0
    v_add_f32 v120, 1.0, v120
    s_add_u32 s77, s77, 27648
    buffer_load_dwordx4 v97, s[52:55], s77 offen offset:3072 lds
    v_add_f32 v121, 1.0, v121
    v_rcp_f32 v120, v120
    v_rcp_f32 v121, v121
    s_nop 0
    v_cvt_pk_bf16_f32 v120, v120, v121
    v_and_b32 v121, 0xffff0000, v120
    v_lshlrev_b32 v120, 16, v120
    s_lshl_b32 s21, s21, 2
    s_add_u32 s21, s21, 14417920
    v_mov_b32 v122, 0
    s_mov_b32 exec_lo, 0
    s_brev_b32 exec_hi, 1
    buffer_store_dwordx2 v[120:121], v122, s[56:59], s21 offen sc1
    s_mov_b64 exec, -1
    s_waitcnt vmcnt(13) lgkmcnt(0)
    s_barrier
    v_add_u32 v15, 0, v8
    ds_read_b128 a[96:99], v15
    v_xor_b32 v12, 32, v15
    ds_read_b128 a[100:103], v12
    v_xor_b32 v12, 64, v15
    ds_read_b128 a[104:107], v12
    v_xor_b32 v12, 96, v15
    ds_read_b128 a[108:111], v12
    v_xor_b32 v12, 128, v15
    ds_read_b128 a[112:115], v12
    v_xor_b32 v12, 160, v15
    ds_read_b128 a[116:119], v12
    v_xor_b32 v12, 192, v15
    ds_read_b128 a[120:123], v12
    v_xor_b32 v12, 224, v15
    ds_read_b128 a[124:127], v12
    s_waitcnt lgkmcnt(0)
    v_add_u32 v12, 147456, v10
    v_add_u32 v13, 147456, v11
    ds_read_b64_tr_b16 v[64:65], v12 offset:0
    ds_read_b64_tr_b16 v[66:67], v12 offset:512
    ds_read_b64_tr_b16 v[68:69], v13 offset:0
    ds_read_b64_tr_b16 v[70:71], v13 offset:512
    ds_read_b64_tr_b16 v[72:73], v12 offset:2048
    ds_read_b64_tr_b16 v[74:75], v12 offset:2560
    ds_read_b64_tr_b16 v[76:77], v13 offset:2048
    ds_read_b64_tr_b16 v[78:79], v13 offset:2560
    ds_read_b64_tr_b16 v[80:81], v12 offset:4096
    ds_read_b64_tr_b16 v[82:83], v12 offset:4608
    ds_read_b64_tr_b16 v[84:85], v13 offset:4096
    ds_read_b64_tr_b16 v[86:87], v13 offset:4608
    s_waitcnt lgkmcnt(8)
    v_mfma_f32_32x32x16_bf16 v[16:31], v[64:67], a[0:3], 0
    s_add_u32 s78, s9, 131072
    s_cmp_eq_u32 s4, 0
    s_cselect_b32 m0, 126976, s78
    s_nop 0
    buffer_load_dwordx4 v99, s[68:71], s15 offen offset:0 lds
    v_mfma_f32_32x32x16_bf16 v[32:47], v[68:71], a[0:3], 0
    ds_read_b64_tr_b16 v[88:89], v12 offset:6144
    ds_read_b64_tr_b16 v[90:91], v12 offset:6656
    ds_read_b64_tr_b16 v[92:93], v13 offset:6144
    ds_read_b64_tr_b16 v[94:95], v13 offset:6656
    v_xor_b32 v100, 32, v99
    v_add_u32 v100, 1024, v100
    buffer_load_dwordx4 v100, s[68:71], s15 offen offset:1024 lds
    s_waitcnt lgkmcnt(8)
    v_mfma_f32_32x32x16_bf16 v[16:31], v[72:75], a[4:7], v[16:31]
    v_xor_b32 v100, 64, v99
    v_add_u32 v100, 2048, v100
    buffer_load_dwordx4 v100, s[68:71], s15 offen offset:2048 lds
    v_mfma_f32_32x32x16_bf16 v[32:47], v[76:79], a[4:7], v[32:47]
    ds_read_b64_tr_b16 v[64:65], v12 offset:8192
    ds_read_b64_tr_b16 v[66:67], v12 offset:8704
    ds_read_b64_tr_b16 v[68:69], v13 offset:8192
    ds_read_b64_tr_b16 v[70:71], v13 offset:8704
    v_xor_b32 v100, 96, v99
    v_add_u32 v100, 3072, v100
    buffer_load_dwordx4 v100, s[68:71], s15 offen offset:3072 lds
    s_waitcnt lgkmcnt(8)
    v_mfma_f32_32x32x16_bf16 v[16:31], v[80:83], a[8:11], v[16:31]
    s_lshl_b32 s78, s4, 13
    s_add_u32 m0, s78, 98304
    s_add_u32 s77, s14, 0
    buffer_load_dwordx4 v98, s[64:67], s77 offen offset:0 lds
    v_mfma_f32_32x32x16_bf16 v[32:47], v[84:87], a[8:11], v[32:47]
    ds_read_b64_tr_b16 v[72:73], v12 offset:10240
    ds_read_b64_tr_b16 v[74:75], v12 offset:10752
    ds_read_b64_tr_b16 v[76:77], v13 offset:10240
    ds_read_b64_tr_b16 v[78:79], v13 offset:10752
    s_add_u32 s77, s77, 7168
    buffer_load_dwordx4 v98, s[64:67], s77 offen offset:1024 lds
    s_waitcnt lgkmcnt(8)
    v_mfma_f32_32x32x16_bf16 v[16:31], v[88:91], a[12:15], v[16:31]
    s_add_u32 s77, s77, 7168
    buffer_load_dwordx4 v98, s[64:67], s77 offen offset:2048 lds
    v_mfma_f32_32x32x16_bf16 v[32:47], v[92:95], a[12:15], v[32:47]
    ds_read_b64_tr_b16 v[80:81], v12 offset:12288
    ds_read_b64_tr_b16 v[82:83], v12 offset:12800
    ds_read_b64_tr_b16 v[84:85], v13 offset:12288
    ds_read_b64_tr_b16 v[86:87], v13 offset:12800
    s_add_u32 s77, s77, 7168
    buffer_load_dwordx4 v98, s[64:67], s77 offen offset:3072 lds
    s_waitcnt lgkmcnt(8)
    v_mfma_f32_32x32x16_bf16 v[16:31], v[64:67], a[16:19], v[16:31]
    s_lshl_b32 s78, s4, 13
    s_add_u32 m0, s78, 102400
    s_add_u32 s77, s14, 32768
    s_cmp_eq_u32 s4, 3
    s_cbranch_scc1 KB_Q0S0
    buffer_load_dwordx4 v98, s[64:67], s77 offen offset:0 lds
KB_Q0S0:
    v_mfma_f32_32x32x16_bf16 v[32:47], v[68:71], a[16:19], v[32:47]
    ds_read_b64_tr_b16 v[88:89], v12 offset:14336
    ds_read_b64_tr_b16 v[90:91], v12 offset:14848
    ds_read_b64_tr_b16 v[92:93], v13 offset:14336
    ds_read_b64_tr_b16 v[94:95], v13 offset:14848
    s_cmp_eq_u32 s4, 3
    s_cbranch_scc1 KB_Q0S1
    s_add_u32 s77, s77, 7168
    buffer_load_dwordx4 v98, s[64:67], s77 offen offset:1024 lds
KB_Q0S1:
    s_waitcnt lgkmcnt(8)
    v_mfma_f32_32x32x16_bf16 v[16:31], v[72:75], a[20:23], v[16:31]
    s_cmp_eq_u32 s4, 3
    s_cbranch_scc1 KB_Q0S2
    s_add_u32 s77, s77, 7168
    buffer_load_dwordx4 v98, s[64:67], s77 offen offset:2048 lds
KB_Q0S2:
    v_mfma_f32_32x32x16_bf16 v[32:47], v[76:79], a[20:23], v[32:47]
    s_cmp_eq_u32 s4, 3
    s_cbranch_scc1 KB_Q0S3
    s_add_u32 s77, s77, 7168
    buffer_load_dwordx4 v98, s[64:67], s77 offen offset:3072 lds
KB_Q0S3:
    s_waitcnt lgkmcnt(4)
    v_mfma_f32_32x32x16_bf16 v[16:31], v[80:83], a[24:27], v[16:31]
    v_mfma_f32_32x32x16_bf16 v[32:47], v[84:87], a[24:27], v[32:47]
    s_waitcnt lgkmcnt(0)
    v_mfma_f32_32x32x16_bf16 v[16:31], v[88:91], a[28:31], v[16:31]
    v_mfma_f32_32x32x16_bf16 v[32:47], v[92:95], a[28:31], v[32:47]
    s_waitcnt vmcnt(9) lgkmcnt(0)
    s_barrier
    s_setprio 1
    ds_read_b64_tr_b16 v[64:65], v10 offset:49152
    ds_read_b64_tr_b16 v[66:67], v10 offset:49664
    ds_read_b64_tr_b16 v[68:69], v11 offset:49152
    ds_read_b64_tr_b16 v[70:71], v11 offset:49664
    ds_read_b64_tr_b16 v[72:73], v10 offset:51200
    ds_read_b64_tr_b16 v[74:75], v10 offset:51712
    ds_read_b64_tr_b16 v[76:77], v11 offset:51200
    ds_read_b64_tr_b16 v[78:79], v11 offset:51712
    ds_read_b64_tr_b16 v[80:81], v10 offset:53248
    ds_read_b64_tr_b16 v[82:83], v10 offset:53760
    ds_read_b64_tr_b16 v[84:85], v11 offset:53248
    ds_read_b64_tr_b16 v[86:87], v11 offset:53760
    s_waitcnt lgkmcnt(8)
    v_mfma_f32_32x32x16_bf16 v[16:31], v[64:67], a[32:35], v[16:31]
    v_mfma_f32_32x32x16_bf16 v[32:47], v[68:71], a[32:35], v[32:47]
    ds_read_b64_tr_b16 v[88:89], v10 offset:55296
    ds_read_b64_tr_b16 v[90:91], v10 offset:55808
    ds_read_b64_tr_b16 v[92:93], v11 offset:55296
    ds_read_b64_tr_b16 v[94:95], v11 offset:55808
    s_waitcnt lgkmcnt(8)
    v_mfma_f32_32x32x16_bf16 v[16:31], v[72:75], a[36:39], v[16:31]
    v_mfma_f32_32x32x16_bf16 v[32:47], v[76:79], a[36:39], v[32:47]
    ds_read_b64_tr_b16 v[64:65], v10 offset:57344
    ds_read_b64_tr_b16 v[66:67], v10 offset:57856
    ds_read_b64_tr_b16 v[68:69], v11 offset:57344
    ds_read_b64_tr_b16 v[70:71], v11 offset:57856
    s_waitcnt lgkmcnt(8)
    v_mfma_f32_32x32x16_bf16 v[16:31], v[80:83], a[40:43], v[16:31]
    v_mfma_f32_32x32x16_bf16 v[32:47], v[84:87], a[40:43], v[32:47]
    ds_read_b64_tr_b16 v[72:73], v10 offset:59392
    ds_read_b64_tr_b16 v[74:75], v10 offset:59904
    ds_read_b64_tr_b16 v[76:77], v11 offset:59392
    ds_read_b64_tr_b16 v[78:79], v11 offset:59904
    s_waitcnt lgkmcnt(8)
    v_mfma_f32_32x32x16_bf16 v[16:31], v[88:91], a[44:47], v[16:31]
    v_mfma_f32_32x32x16_bf16 v[32:47], v[92:95], a[44:47], v[32:47]
    ds_read_b64_tr_b16 v[80:81], v10 offset:61440
    ds_read_b64_tr_b16 v[82:83], v10 offset:61952
    ds_read_b64_tr_b16 v[84:85], v11 offset:61440
    ds_read_b64_tr_b16 v[86:87], v11 offset:61952
    s_waitcnt lgkmcnt(8)
    v_mfma_f32_32x32x16_bf16 v[16:31], v[64:67], a[48:51], v[16:31]
    v_mfma_f32_32x32x16_bf16 v[32:47], v[68:71], a[48:51], v[32:47]
    ds_read_b64_tr_b16 v[88:89], v10 offset:63488
    ds_read_b64_tr_b16 v[90:91], v10 offset:64000
    ds_read_b64_tr_b16 v[92:93], v11 offset:63488
    ds_read_b64_tr_b16 v[94:95], v11 offset:64000
    s_waitcnt lgkmcnt(8)
    v_mfma_f32_32x32x16_bf16 v[16:31], v[72:75], a[52:55], v[16:31]
    v_mfma_f32_32x32x16_bf16 v[32:47], v[76:79], a[52:55], v[32:47]
    s_waitcnt lgkmcnt(4)
    v_mfma_f32_32x32x16_bf16 v[16:31], v[80:83], a[56:59], v[16:31]
    v_mfma_f32_32x32x16_bf16 v[32:47], v[84:87], a[56:59], v[32:47]
    s_waitcnt lgkmcnt(0)
    v_mfma_f32_32x32x16_bf16 v[16:31], v[88:91], a[60:63], v[16:31]
    v_mfma_f32_32x32x16_bf16 v[32:47], v[92:95], a[60:63], v[32:47]
    s_waitcnt vmcnt(0)
    v_mov_b32 v12, 134144
    v_mov_b32 v13, 1
    s_mov_b64 exec, 1
    ds_add_u32 v12, v13
    s_mov_b64 exec, -1
KB_ESY0:
    ds_read_b32 v13, v12
    s_waitcnt lgkmcnt(0)
    v_readfirstlane_b32 s77, v13
    s_nop 0
    s_cmp_lt_u32 s77, 4
    s_cbranch_scc1 KB_ESY0
    s_mov_b32 s72, s40
    s_and_b32 s73, s41, 0xffff
    s_mov_b32 s74, 256
    s_mov_b32 s75, 0x20000
    v_mov_b32 v101, 0
    buffer_load_dword v101, v101, s[72:75], 0 offen sc1
    v_lshrrev_b32 v12, 5, v0
    v_lshlrev_b32 v12, 2, v12
    v_bfe_u32 v13, v0, 2, 2
    v_add_u32 v12, v12, v13
    v_lshlrev_b32 v12, 7, v12
    v_bfe_u32 v13, v0, 3, 1
    v_lshl_add_u32 v12, v13, 6, v12
    v_bfe_u32 v13, v0, 4, 1
    v_lshl_add_u32 v12, v13, 5, v12
    v_and_b32 v13, 3, v0
    v_lshl_add_u32 v12, v13, 3, v12
    s_and_b32 s76, s4, 1
    s_lshl_b32 s77, s76, 6
    v_xor_b32 v12, s77, v12
    s_lshr_b32 s77, s4, 1
    s_mul_i32 s78, s77, 14336
    s_add_u32 s78, s78, 98304
    v_add_u32 v12, s78, v12
    ds_read_b64_tr_b16 v[64:65], v12 offset:0
    ds_read_b64_tr_b16 v[66:67], v12 offset:1024
    ds_read_b64_tr_b16 v[68:69], v12 offset:2048
    ds_read_b64_tr_b16 v[70:71], v12 offset:3072
    ds_read_b64_tr_b16 v[72:73], v12 offset:4096
    ds_read_b64_tr_b16 v[74:75], v12 offset:5120
    ds_read_b64_tr_b16 v[76:77], v12 offset:6144
    ds_read_b64_tr_b16 v[78:79], v12 offset:7168
    ds_read_b64_tr_b16 v[48:49], v12 offset:8192
    ds_read_b64_tr_b16 v[50:51], v12 offset:9216
    ds_read_b64_tr_b16 v[52:53], v12 offset:10240
    ds_read_b64_tr_b16 v[54:55], v12 offset:11264
    ds_read_b64_tr_b16 v[56:57], v12 offset:12288
    ds_read_b64_tr_b16 v[58:59], v12 offset:13312
    s_and_b32 s78, s13, 7
    s_lshl_b32 s78, s78, 1
    s_add_u32 s78, s78, s76
    s_mul_i32 s78, s78, 180224
    s_lshr_b32 s79, s13, 3
    s_mul_i32 s79, s79, 14
    s_mul_i32 s77, s77, 7
    s_add_u32 s79, s79, s77
    s_lshl_b32 s79, s79, 10
    s_add_u32 s78, s78, s79
    s_add_u32 s78, s78, 11534336
    s_add_u32 s79, s78, 4096
    s_waitcnt lgkmcnt(12)
    buffer_store_dwordx4 v[64:67], v14, s[56:59], s78 offen offset:0 sc1
    s_waitcnt lgkmcnt(10)
    buffer_store_dwordx4 v[68:71], v14, s[56:59], s78 offen offset:1024 sc1
    s_waitcnt lgkmcnt(8)
    buffer_store_dwordx4 v[72:75], v14, s[56:59], s78 offen offset:2048 sc1
    s_waitcnt lgkmcnt(6)
    buffer_store_dwordx4 v[76:79], v14, s[56:59], s78 offen offset:3072 sc1
    s_waitcnt lgkmcnt(4)
    buffer_store_dwordx4 v[48:51], v14, s[56:59], s79 offen offset:0 sc1
    s_waitcnt lgkmcnt(2)
    buffer_store_dwordx4 v[52:55], v14, s[56:59], s79 offen offset:1024 sc1
    s_waitcnt lgkmcnt(0)
    buffer_store_dwordx4 v[56:59], v14, s[56:59], s79 offen offset:2048 sc1
    v_and_b32 v12, 31, v0
    v_lshrrev_b32 v13, 5, v0
    v_and_b32 v15, 15, v0
    v_xor_b32 v13, v13, v15
    v_lshlrev_b32 v13, 4, v13
    v_lshrrev_b32 v15, 3, v12
    v_and_b32 v12, 7, v12
    v_lshl_add_u32 v12, v12, 9, v13
    v_lshlrev_b32 v13, 12, v15
    v_add_u32 v13, 131072, v13
    v_cmp_eq_u32 vcc, 0, v15
    v_mov_b32 v15, 126976
    s_nop 0
    v_cndmask_b32 v13, v13, v15, vcc
    s_lshl_b32 s76, s4, 7
    v_xor_b32 v12, s76, v12
    v_add_u32 v12, v13, v12
    s_nop 1
    ds_read_b128 v[64:67], v12
    v_xor_b32 v13, 32, v12
    ds_read_b128 v[68:71], v13
    v_xor_b32 v13, 64, v12
    ds_read_b128 v[72:75], v13
    v_xor_b32 v13, 96, v12
    ds_read_b128 v[76:79], v13
    s_lshr_b32 s76, s13, 1
    s_and_b32 s76, s76, 15
    s_mul_i32 s76, s76, 180224
    s_and_b32 s77, s13, 1
    s_lshl_b32 s77, s77, 5
    s_lshl_b32 s78, s4, 3
    s_add_u32 s77, s77, s78
    s_lshr_b32 s78, s13, 5
    s_lshl_b32 s78, s78, 1
    s_add_u32 s77, s77, s78
    s_add_u32 s77, s77, 112
    s_lshl_b32 s77, s77, 10
    s_add_u32 s76, s76, s77
    s_add_u32 s76, s76, 11534336
    s_add_u32 s77, s76, 4096
    s_waitcnt lgkmcnt(3)
    buffer_store_dwordx4 v[64:67], v14, s[56:59], s76 offen offset:0 sc1
    s_waitcnt lgkmcnt(2)
    buffer_store_dwordx4 v[68:71], v14, s[56:59], s76 offen offset:1024 sc1
    s_waitcnt lgkmcnt(1)
    buffer_store_dwordx4 v[72:75], v14, s[56:59], s77 offen offset:0 sc1
    s_waitcnt lgkmcnt(0)
    buffer_store_dwordx4 v[76:79], v14, s[56:59], s77 offen offset:1024 sc1
    v_add_u32 v12, 65536, v10
    v_add_u32 v13, 65536, v11
    ds_read_b64_tr_b16 v[64:65], v12 offset:0
    ds_read_b64_tr_b16 v[66:67], v12 offset:512
    ds_read_b64_tr_b16 v[68:69], v13 offset:0
    ds_read_b64_tr_b16 v[70:71], v13 offset:512
    ds_read_b64_tr_b16 v[72:73], v12 offset:2048
    ds_read_b64_tr_b16 v[74:75], v12 offset:2560
    ds_read_b64_tr_b16 v[76:77], v13 offset:2048
    ds_read_b64_tr_b16 v[78:79], v13 offset:2560
    ds_read_b64_tr_b16 v[80:81], v12 offset:4096
    ds_read_b64_tr_b16 v[82:83], v12 offset:4608
    ds_read_b64_tr_b16 v[84:85], v13 offset:4096
    ds_read_b64_tr_b16 v[86:87], v13 offset:4608
    s_waitcnt lgkmcnt(8)
    v_mfma_f32_32x32x16_bf16 v[16:31], v[64:67], a[64:67], v[16:31]
    v_mfma_f32_32x32x16_bf16 v[32:47], v[68:71], a[64:67], v[32:47]
    ds_read_b64_tr_b16 v[88:89], v12 offset:6144
    ds_read_b64_tr_b16 v[90:91], v12 offset:6656
    ds_read_b64_tr_b16 v[92:93], v13 offset:6144
    ds_read_b64_tr_b16 v[94:95], v13 offset:6656
    s_waitcnt lgkmcnt(8)
    v_mfma_f32_32x32x16_bf16 v[16:31], v[72:75], a[68:71], v[16:31]
    v_mfma_f32_32x32x16_bf16 v[32:47], v[76:79], a[68:71], v[32:47]
    ds_read_b64_tr_b16 v[64:65], v12 offset:8192
    ds_read_b64_tr_b16 v[66:67], v12 offset:8704
    ds_read_b64_tr_b16 v[68:69], v13 offset:8192
    ds_read_b64_tr_b16 v[70:71], v13 offset:8704
    s_waitcnt lgkmcnt(8)
    v_mfma_f32_32x32x16_bf16 v[16:31], v[80:83], a[72:75], v[16:31]
    v_mfma_f32_32x32x16_bf16 v[32:47], v[84:87], a[72:75], v[32:47]
    ds_read_b64_tr_b16 v[72:73], v12 offset:10240
    ds_read_b64_tr_b16 v[74:75], v12 offset:10752
    ds_read_b64_tr_b16 v[76:77], v13 offset:10240
    ds_read_b64_tr_b16 v[78:79], v13 offset:10752
    s_waitcnt lgkmcnt(8)
    v_mfma_f32_32x32x16_bf16 v[16:31], v[88:91], a[76:79], v[16:31]
    v_mfma_f32_32x32x16_bf16 v[32:47], v[92:95], a[76:79], v[32:47]
    ds_read_b64_tr_b16 v[80:81], v12 offset:12288
    ds_read_b64_tr_b16 v[82:83], v12 offset:12800
    ds_read_b64_tr_b16 v[84:85], v13 offset:12288
    ds_read_b64_tr_b16 v[86:87], v13 offset:12800
    s_waitcnt lgkmcnt(8)
    v_mfma_f32_32x32x16_bf16 v[16:31], v[64:67], a[80:83], v[16:31]
    v_mfma_f32_32x32x16_bf16 v[32:47], v[68:71], a[80:83], v[32:47]
    ds_read_b64_tr_b16 v[88:89], v12 offset:14336
    ds_read_b64_tr_b16 v[90:91], v12 offset:14848
    ds_read_b64_tr_b16 v[92:93], v13 offset:14336
    ds_read_b64_tr_b16 v[94:95], v13 offset:14848
    s_waitcnt lgkmcnt(8)
    v_mfma_f32_32x32x16_bf16 v[16:31], v[72:75], a[84:87], v[16:31]
    v_mfma_f32_32x32x16_bf16 v[32:47], v[76:79], a[84:87], v[32:47]
    s_waitcnt lgkmcnt(4)
    v_mfma_f32_32x32x16_bf16 v[16:31], v[80:83], a[88:91], v[16:31]
    v_mfma_f32_32x32x16_bf16 v[32:47], v[84:87], a[88:91], v[32:47]
    s_waitcnt lgkmcnt(0)
    v_mfma_f32_32x32x16_bf16 v[16:31], v[88:91], a[92:95], v[16:31]
    v_mfma_f32_32x32x16_bf16 v[32:47], v[92:95], a[92:95], v[32:47]
    v_add_u32 v12, 81920, v10
    v_add_u32 v13, 81920, v11
    ds_read_b64_tr_b16 v[64:65], v12 offset:0
    ds_read_b64_tr_b16 v[66:67], v12 offset:512
    ds_read_b64_tr_b16 v[68:69], v13 offset:0
    ds_read_b64_tr_b16 v[70:71], v13 offset:512
    ds_read_b64_tr_b16 v[72:73], v12 offset:2048
    ds_read_b64_tr_b16 v[74:75], v12 offset:2560
    ds_read_b64_tr_b16 v[76:77], v13 offset:2048
    ds_read_b64_tr_b16 v[78:79], v13 offset:2560
    ds_read_b64_tr_b16 v[80:81], v12 offset:4096
    ds_read_b64_tr_b16 v[82:83], v12 offset:4608
    ds_read_b64_tr_b16 v[84:85], v13 offset:4096
    ds_read_b64_tr_b16 v[86:87], v13 offset:4608
    s_waitcnt lgkmcnt(8)
    v_mfma_f32_32x32x16_bf16 v[16:31], v[64:67], a[96:99], v[16:31]
    v_mfma_f32_32x32x16_bf16 v[32:47], v[68:71], a[96:99], v[32:47]
    ds_read_b64_tr_b16 v[88:89], v12 offset:6144
    ds_read_b64_tr_b16 v[90:91], v12 offset:6656
    ds_read_b64_tr_b16 v[92:93], v13 offset:6144
    ds_read_b64_tr_b16 v[94:95], v13 offset:6656
    s_waitcnt lgkmcnt(8)
    v_mfma_f32_32x32x16_bf16 v[16:31], v[72:75], a[100:103], v[16:31]
    v_mfma_f32_32x32x16_bf16 v[32:47], v[76:79], a[100:103], v[32:47]
    ds_read_b64_tr_b16 v[64:65], v12 offset:8192
    ds_read_b64_tr_b16 v[66:67], v12 offset:8704
    ds_read_b64_tr_b16 v[68:69], v13 offset:8192
    ds_read_b64_tr_b16 v[70:71], v13 offset:8704
    s_waitcnt lgkmcnt(8)
    v_mfma_f32_32x32x16_bf16 v[16:31], v[80:83], a[104:107], v[16:31]
    v_mfma_f32_32x32x16_bf16 v[32:47], v[84:87], a[104:107], v[32:47]
    ds_read_b64_tr_b16 v[72:73], v12 offset:10240
    ds_read_b64_tr_b16 v[74:75], v12 offset:10752
    ds_read_b64_tr_b16 v[76:77], v13 offset:10240
    ds_read_b64_tr_b16 v[78:79], v13 offset:10752
    s_waitcnt lgkmcnt(8)
    v_mfma_f32_32x32x16_bf16 v[16:31], v[88:91], a[108:111], v[16:31]
    v_mfma_f32_32x32x16_bf16 v[32:47], v[92:95], a[108:111], v[32:47]
    ds_read_b64_tr_b16 v[80:81], v12 offset:12288
    ds_read_b64_tr_b16 v[82:83], v12 offset:12800
    ds_read_b64_tr_b16 v[84:85], v13 offset:12288
    ds_read_b64_tr_b16 v[86:87], v13 offset:12800
    s_waitcnt lgkmcnt(8)
    v_mfma_f32_32x32x16_bf16 v[16:31], v[64:67], a[112:115], v[16:31]
    v_mfma_f32_32x32x16_bf16 v[32:47], v[68:71], a[112:115], v[32:47]
    ds_read_b64_tr_b16 v[88:89], v12 offset:14336
    ds_read_b64_tr_b16 v[90:91], v12 offset:14848
    ds_read_b64_tr_b16 v[92:93], v13 offset:14336
    ds_read_b64_tr_b16 v[94:95], v13 offset:14848
    s_waitcnt lgkmcnt(8)
    v_mfma_f32_32x32x16_bf16 v[16:31], v[72:75], a[116:119], v[16:31]
    v_mfma_f32_32x32x16_bf16 v[32:47], v[76:79], a[116:119], v[32:47]
    s_waitcnt lgkmcnt(4)
    v_mfma_f32_32x32x16_bf16 v[16:31], v[80:83], a[120:123], v[16:31]
    v_mfma_f32_32x32x16_bf16 v[32:47], v[84:87], a[120:123], v[32:47]
    s_waitcnt lgkmcnt(0)
    v_mfma_f32_32x32x16_bf16 v[16:31], v[88:91], a[124:127], v[16:31]
    v_mfma_f32_32x32x16_bf16 v[32:47], v[92:95], a[124:127], v[32:47]
    s_waitcnt vmcnt(0)
    v_mov_b32 v12, 134144
    v_mov_b32 v13, 1
    s_mov_b64 exec, 1
    ds_add_u32 v12, v13
    s_mov_b64 exec, -1
KB_ESY2:
    ds_read_b32 v13, v12
    s_waitcnt lgkmcnt(0)
    v_readfirstlane_b32 s77, v13
    s_nop 0
    s_cmp_lt_u32 s77, 8
    s_cbranch_scc1 KB_ESY2
    s_cmp_lg_u32 s4, 0
    s_cbranch_scc1 KB_NOWFP
    v_readfirstlane_b32 s77, v101
    s_mov_b32 s81, 0
    s_nop 2
KB_WFN:
    s_cmp_lg_u32 s77, 0
    s_cbranch_scc1 KB_WFNOK
    s_add_u32 s81, s81, 1
    s_cmp_gt_u32 s81, 300000
    s_cbranch_scc1 KB_WFNOK
    v_mov_b32 v101, 0
    buffer_load_dword v101, v101, s[72:75], 0 offen sc1
    s_waitcnt vmcnt(0)
    v_readfirstlane_b32 s77, v101
    s_nop 3
    s_branch KB_WFN
KB_WFNOK:
    s_lshl_b32 s76, s13, 7
    s_add_u32 s76, s76, 14647296
    v_mov_b32 v12, 0
    v_mov_b32 v13, s77
    s_mov_b64 exec, 1
    buffer_store_dword v13, v12, s[56:59], s76 offen sc1
    s_mov_b64 exec, -1
KB_NOWFP:
    s_lshr_b32 s76, s7, 5
    s_lshl_b32 s76, s76, 10
    s_add_u32 s76, s76, s80
    s_nop 7
    v_cvt_pk_bf16_f32 v122, v16, v17
    v_cvt_pk_bf16_f32 v123, v18, v19
    v_cvt_pk_bf16_f32 v124, v20, v21
    v_cvt_pk_bf16_f32 v125, v22, v23
    v_lshlrev_b32 v16, 16, v122
    v_and_b32 v17, s20, v122
    v_lshlrev_b32 v18, 16, v123
    v_and_b32 v19, s20, v123
    v_lshlrev_b32 v20, 16, v124
    v_and_b32 v21, s20, v124
    v_lshlrev_b32 v22, 16, v125
    v_and_b32 v23, s20, v125
    v_mul_f32 v114, s16, v16
    v_mul_f32 v115, s16, v17
    v_mul_f32 v116, s16, v18
    v_mul_f32 v117, s16, v19
    v_mul_f32 v118, s16, v20
    v_mul_f32 v119, s16, v21
    v_mul_f32 v120, s16, v22
    v_mul_f32 v121, s16, v23
    v_exp_f32 v114, v114
    v_exp_f32 v115, v115
    v_exp_f32 v116, v116
    v_exp_f32 v117, v117
    v_exp_f32 v118, v118
    v_exp_f32 v119, v119
    v_exp_f32 v120, v120
    v_exp_f32 v121, v121
    v_add_f32 v114, 1.0, v114
    v_add_f32 v115, 1.0, v115
    v_add_f32 v116, 1.0, v116
    v_add_f32 v117, 1.0, v117
    v_add_f32 v118, 1.0, v118
    v_add_f32 v119, 1.0, v119
    v_add_f32 v120, 1.0, v120
    v_add_f32 v121, 1.0, v121
    v_rcp_f32 v114, v114
    v_rcp_f32 v115, v115
    v_rcp_f32 v116, v116
    v_rcp_f32 v117, v117
    v_rcp_f32 v118, v118
    v_rcp_f32 v119, v119
    v_rcp_f32 v120, v120
    v_rcp_f32 v121, v121
    v_mul_f32 v16, v16, v114
    v_mul_f32 v17, v17, v115
    v_mul_f32 v18, v18, v116
    v_mul_f32 v19, v19, v117
    v_mul_f32 v20, v20, v118
    v_mul_f32 v21, v21, v119
    v_mul_f32 v22, v22, v120
    v_mul_f32 v23, v23, v121
    v_cvt_pk_bf16_f32 v16, v16, v17
    v_cvt_pk_bf16_f32 v17, v18, v19
    v_cvt_pk_bf16_f32 v18, v20, v21
    v_cvt_pk_bf16_f32 v19, v22, v23
    buffer_store_dwordx4 v[16:19], v14, s[56:59], s76 offen offset:0 sc1
    v_cvt_pk_bf16_f32 v122, v24, v25
    v_cvt_pk_bf16_f32 v123, v26, v27
    v_cvt_pk_bf16_f32 v124, v28, v29
    v_cvt_pk_bf16_f32 v125, v30, v31
    v_lshlrev_b32 v24, 16, v122
    v_and_b32 v25, s20, v122
    v_lshlrev_b32 v26, 16, v123
    v_and_b32 v27, s20, v123
    v_lshlrev_b32 v28, 16, v124
    v_and_b32 v29, s20, v124
    v_lshlrev_b32 v30, 16, v125
    v_and_b32 v31, s20, v125
    v_mul_f32 v114, s16, v24
    v_mul_f32 v115, s16, v25
    v_mul_f32 v116, s16, v26
    v_mul_f32 v117, s16, v27
    v_mul_f32 v118, s16, v28
    v_mul_f32 v119, s16, v29
    v_mul_f32 v120, s16, v30
    v_mul_f32 v121, s16, v31
    v_exp_f32 v114, v114
    v_exp_f32 v115, v115
    v_exp_f32 v116, v116
    v_exp_f32 v117, v117
    v_exp_f32 v118, v118
    v_exp_f32 v119, v119
    v_exp_f32 v120, v120
    v_exp_f32 v121, v121
    v_add_f32 v114, 1.0, v114
    v_add_f32 v115, 1.0, v115
    v_add_f32 v116, 1.0, v116
    v_add_f32 v117, 1.0, v117
    v_add_f32 v118, 1.0, v118
    v_add_f32 v119, 1.0, v119
    v_add_f32 v120, 1.0, v120
    v_add_f32 v121, 1.0, v121
    v_rcp_f32 v114, v114
    v_rcp_f32 v115, v115
    v_rcp_f32 v116, v116
    v_rcp_f32 v117, v117
    v_rcp_f32 v118, v118
    v_rcp_f32 v119, v119
    v_rcp_f32 v120, v120
    v_rcp_f32 v121, v121
    v_mul_f32 v24, v24, v114
    v_mul_f32 v25, v25, v115
    v_mul_f32 v26, v26, v116
    v_mul_f32 v27, v27, v117
    v_mul_f32 v28, v28, v118
    v_mul_f32 v29, v29, v119
    v_mul_f32 v30, v30, v120
    v_mul_f32 v31, v31, v121
    v_cvt_pk_bf16_f32 v24, v24, v25
    v_cvt_pk_bf16_f32 v25, v26, v27
    v_cvt_pk_bf16_f32 v26, v28, v29
    v_cvt_pk_bf16_f32 v27, v30, v31
    buffer_store_dwordx4 v[24:27], v14, s[56:59], s76 offen offset:1024 sc1
    s_mov_b32 s72, s40
    s_and_b32 s73, s41, 0xffff
    s_mov_b32 s74, 256
    s_mov_b32 s75, 0x20000
    v_mov_b32 v101, 0
    buffer_load_dword v101, v101, s[72:75], 0 offen sc1
    v_cvt_pk_bf16_f32 v122, v32, v33
    v_cvt_pk_bf16_f32 v123, v34, v35
    v_cvt_pk_bf16_f32 v124, v36, v37
    v_cvt_pk_bf16_f32 v125, v38, v39
    v_lshlrev_b32 v32, 16, v122
    v_and_b32 v33, s20, v122
    v_lshlrev_b32 v34, 16, v123
    v_and_b32 v35, s20, v123
    v_lshlrev_b32 v36, 16, v124
    v_and_b32 v37, s20, v124
    v_lshlrev_b32 v38, 16, v125
    v_and_b32 v39, s20, v125
    v_mul_f32 v114, s16, v32
    v_mul_f32 v115, s16, v33
    v_mul_f32 v116, s16, v34
    v_mul_f32 v117, s16, v35
    v_mul_f32 v118, s16, v36
    v_mul_f32 v119, s16, v37
    v_mul_f32 v120, s16, v38
    v_mul_f32 v121, s16, v39
    v_exp_f32 v114, v114
    v_exp_f32 v115, v115
    v_exp_f32 v116, v116
    v_exp_f32 v117, v117
    v_exp_f32 v118, v118
    v_exp_f32 v119, v119
    v_exp_f32 v120, v120
    v_exp_f32 v121, v121
    v_add_f32 v114, 1.0, v114
    v_add_f32 v115, 1.0, v115
    v_add_f32 v116, 1.0, v116
    v_add_f32 v117, 1.0, v117
    v_add_f32 v118, 1.0, v118
    v_add_f32 v119, 1.0, v119
    v_add_f32 v120, 1.0, v120
    v_add_f32 v121, 1.0, v121
    v_rcp_f32 v114, v114
    v_rcp_f32 v115, v115
    v_rcp_f32 v116, v116
    v_rcp_f32 v117, v117
    v_rcp_f32 v118, v118
    v_rcp_f32 v119, v119
    v_rcp_f32 v120, v120
    v_rcp_f32 v121, v121
    v_mul_f32 v32, v32, v114
    v_mul_f32 v33, v33, v115
    v_mul_f32 v34, v34, v116
    v_mul_f32 v35, v35, v117
    v_mul_f32 v36, v36, v118
    v_mul_f32 v37, v37, v119
    v_mul_f32 v38, v38, v120
    v_mul_f32 v39, v39, v121
    v_cvt_pk_bf16_f32 v32, v32, v33
    v_cvt_pk_bf16_f32 v33, v34, v35
    v_cvt_pk_bf16_f32 v34, v36, v37
    v_cvt_pk_bf16_f32 v35, v38, v39
    buffer_store_dwordx4 v[32:35], v14, s[56:59], s76 offen offset:2048 sc1
    v_cvt_pk_bf16_f32 v122, v40, v41
    v_cvt_pk_bf16_f32 v123, v42, v43
    v_cvt_pk_bf16_f32 v124, v44, v45
    v_cvt_pk_bf16_f32 v125, v46, v47
    v_lshlrev_b32 v40, 16, v122
    v_and_b32 v41, s20, v122
    v_lshlrev_b32 v42, 16, v123
    v_and_b32 v43, s20, v123
    v_lshlrev_b32 v44, 16, v124
    v_and_b32 v45, s20, v124
    v_lshlrev_b32 v46, 16, v125
    v_and_b32 v47, s20, v125
    v_mul_f32 v114, s16, v40
    v_mul_f32 v115, s16, v41
    v_mul_f32 v116, s16, v42
    v_mul_f32 v117, s16, v43
    v_mul_f32 v118, s16, v44
    v_mul_f32 v119, s16, v45
    v_mul_f32 v120, s16, v46
    v_mul_f32 v121, s16, v47
    v_exp_f32 v114, v114
    v_exp_f32 v115, v115
    v_exp_f32 v116, v116
    v_exp_f32 v117, v117
    v_exp_f32 v118, v118
    v_exp_f32 v119, v119
    v_exp_f32 v120, v120
    v_exp_f32 v121, v121
    v_add_f32 v114, 1.0, v114
    v_add_f32 v115, 1.0, v115
    v_add_f32 v116, 1.0, v116
    v_add_f32 v117, 1.0, v117
    v_add_f32 v118, 1.0, v118
    v_add_f32 v119, 1.0, v119
    v_add_f32 v120, 1.0, v120
    v_add_f32 v121, 1.0, v121
    v_rcp_f32 v114, v114
    v_rcp_f32 v115, v115
    v_rcp_f32 v116, v116
    v_rcp_f32 v117, v117
    v_rcp_f32 v118, v118
    v_rcp_f32 v119, v119
    v_rcp_f32 v120, v120
    v_rcp_f32 v121, v121
    v_mul_f32 v40, v40, v114
    v_mul_f32 v41, v41, v115
    v_mul_f32 v42, v42, v116
    v_mul_f32 v43, v43, v117
    v_mul_f32 v44, v44, v118
    v_mul_f32 v45, v45, v119
    v_mul_f32 v46, v46, v120
    v_mul_f32 v47, v47, v121
    v_cvt_pk_bf16_f32 v40, v40, v41
    v_cvt_pk_bf16_f32 v41, v42, v43
    v_cvt_pk_bf16_f32 v42, v44, v45
    v_cvt_pk_bf16_f32 v43, v46, v47
    buffer_store_dwordx4 v[40:43], v14, s[56:59], s76 offen offset:3072 sc1
    s_branch KB_P2
K1_AWAVE:
    s_setprio 1
    s_waitcnt lgkmcnt(0)
    s_mov_b32 s72, s40
    s_and_b32 s73, s41, 0xffff
    s_mov_b32 s74, 256
    s_mov_b32 s75, 0x20000
    s_or_b32 s76, s2, s3
    s_cmp_lg_u32 s76, 0
    s_cbranch_scc1 K1_NONONCE
    s_memrealtime s[76:77]
    s_waitcnt lgkmcnt(0)
    s_or_b32 s76, s76, 1
    v_mov_b32 v12, s76
    v_mov_b32 v13, 0
    s_mov_b64 exec, 1
    buffer_store_dword v12, v13, s[72:75], 0 offen sc1
    s_mov_b64 exec, -1
K1_NONONCE:
    v_and_b32 v12, 31, v0
    s_lshl_b32 s76, s6, 5
    v_add_u32 v12, s76, v12
    v_lshlrev_b32 v12, 1, v12
    s_mov_b32 s60, s18
    s_and_b32 s61, s19, 0xffff
    s_mov_b32 s62, 1024
    s_mov_b32 s63, 0x20000
    buffer_load_ushort v113, v12, s[60:63], 0 offen
    s_mov_b32 s60, s20
    s_and_b32 s61, s21, 0xffff
    s_mov_b32 s62, 1024
    s_mov_b32 s63, 0x20000
    buffer_load_ushort v114, v12, s[60:63], 0 offen
    s_mov_b32 s60, s30
    s_and_b32 s61, s31, 0xffff
    s_mov_b32 s62, 1024
    s_mov_b32 s63, 0x20000
    buffer_load_ushort v115, v12, s[60:63], 0 offen
    s_mov_b32 s44, s16
    s_and_b32 s45, s17, 0xffff
    s_mov_b32 s46, 2097152
    s_mov_b32 s47, 0x20000
    s_lshr_b32 s76, s2, 3
    s_and_b32 s76, s76, 3
    s_cmp_lg_u32 s76, s4
    s_cbranch_scc1 KA_NOPF
    s_getpc_b64 s[30:31]
K1_PC:
    s_sub_u32 s60, s30, K1_PC-gated_mix__ssm_conv_s5__dense_activation_silu__prompt_kernel
    s_subb_u32 s61, s31, 0
    s_and_b32 s61, s61, 0xffff
    s_mov_b32 s62, K1_END+4-gated_mix__ssm_conv_s5__dense_activation_silu__prompt_kernel
    s_mov_b32 s63, 0x20000
    s_mul_i32 s76, s4, 8192
    s_add_u32 s77, s76, 4096
    v_lshlrev_b32 v13, 4, v0
    buffer_load_dwordx4 v[60:63], v13, s[60:63], s76 offen offset:0
    buffer_load_dwordx4 v[60:63], v13, s[60:63], s76 offen offset:1024
    buffer_load_dwordx4 v[60:63], v13, s[60:63], s76 offen offset:2048
    buffer_load_dwordx4 v[60:63], v13, s[60:63], s76 offen offset:3072
    buffer_load_dwordx4 v[60:63], v13, s[60:63], s77 offen offset:0
    buffer_load_dwordx4 v[60:63], v13, s[60:63], s77 offen offset:1024
    buffer_load_dwordx4 v[60:63], v13, s[60:63], s77 offen offset:2048
    buffer_load_dwordx4 v[60:63], v13, s[60:63], s77 offen offset:3072
KA_NOPF:
    s_mov_b32 s44, s16
    s_and_b32 s45, s17, 0xffff
    s_mov_b32 s46, 2097152
    s_mov_b32 s47, 0x20000
    v_and_b32 v12, 31, v0
    v_lshrrev_b32 v13, 5, v0
    v_and_b32 v15, 15, v0
    v_xor_b32 v13, v13, v15
    v_lshlrev_b32 v13, 4, v13
    v_lshl_add_u32 v9, v12, 8, v13
    s_lshl_b32 s76, s4, 13
    v_add_u32 v8, s76, v9
    v_lshrrev_b32 v12, 5, v0
    v_lshlrev_b32 v12, 3, v12
    v_bfe_u32 v13, v0, 2, 2
    v_add_u32 v12, v12, v13
    v_lshlrev_b32 v12, 7, v12
    v_bfe_u32 v13, v0, 3, 1
    v_lshl_add_u32 v12, v13, 6, v12
    v_bfe_u32 v13, v0, 4, 1
    v_lshl_add_u32 v12, v13, 5, v12
    v_and_b32 v13, 3, v0
    v_lshl_add_u32 v10, v13, 3, v12
    v_xor_b32 v11, 64, v10
    v_lshlrev_b32 v14, 4, v0
    s_mov_b32 s56, s42
    s_and_b32 s57, s43, 0xffff
    s_mov_b32 s58, 14655488
    s_mov_b32 s59, 0x20000
    s_lshl_b32 s80, s5, 2
    s_add_u32 s80, s80, s4
    s_mul_i32 s80, s80, 180224
    s_lshl_b32 s76, s6, 13
    s_add_u32 s76, s76, 14483456
    s_add_u32 s68, s42, s76
    s_addc_u32 s69, s43, 0
    s_and_b32 s69, s69, 0xffff
    s_mov_b32 s70, 8192
    s_mov_b32 s71, 0x20000
    s_mov_b32 s16, 0xbfb8aa3b
    s_mov_b32 s17, 0xbfb8aa3b
    s_mov_b32 s18, 1.0
    s_mov_b32 s19, 1.0
    s_mov_b32 s20, 0xffff0000
    s_waitcnt vmcnt(0)
    v_lshlrev_b32 v72, 16, v113
    v_lshlrev_b32 v73, 16, v114
    v_lshlrev_b32 v74, 16, v115
    v_mul_f32 v75, 0x3fb8aa3b, v74
    v_exp_f32 v75, v75
    s_nop 0
    v_cvt_pk_bf16_f32 v75, v75, v75
    v_and_b32 v75, 0xffff0000, v75
    v_mul_f32 v76, v75, v72
    v_mul_f32 v77, v75, v73
    v_mul_f32 v76, 0x3fb8aa3b, v76
    v_exp_f32 v76, v76
    v_mul_f32 v77, 0x3e22f983, v77
    v_rndne_f32 v78, v77
    v_sub_f32 v77, v77, v78
    v_sin_f32 v78, v77
    v_cos_f32 v79, v77
    s_nop 0
    v_mul_f32 v97, v76, v78
    v_mul_f32 v96, v76, v79
    v_add_f32 v80, -1.0, v96
    v_cmp_ge_f32 vcc, |v72|, |v73|
    s_nop 1
    v_cndmask_b32 v81, v73, v72, vcc
    v_cndmask_b32 v82, v72, v73, vcc
    v_cndmask_b32 v83, v97, v80, vcc
    v_cndmask_b32 v84, v80, v97, vcc
    v_rcp_f32 v86, v81
    s_nop 0
    v_mul_f32 v86, v82, v86
    v_fma_f32 v87, v82, v86, v81
    v_rcp_f32 v87, v87
    v_fma_f32 v88, v84, v86, v83
    v_fma_f32 v89, -v83, v86, v84
    v_mul_f32 v98, v88, v87
    v_mul_f32 v89, v89, v87
    v_sub_f32 v88, 0, v89
    v_cndmask_b32 v99, v88, v89, vcc
    v_mul_f32 v90, v97, v97
    v_mul_f32 v81, v96, v97
    v_fma_f32 v80, v96, v96, -v90
    v_add_f32 v81, v81, v81
    v_mul_f32 v90, v81, v81
    v_mul_f32 v83, v80, v81
    v_fma_f32 v82, v80, v80, -v90
    v_add_f32 v83, v83, v83
    v_mul_f32 v90, v83, v83
    v_mul_f32 v111, v82, v83
    v_fma_f32 v110, v82, v82, -v90
    v_add_f32 v111, v111, v111
    v_mul_f32 v90, v111, v111
    v_mul_f32 v101, v110, v111
    v_fma_f32 v100, v110, v110, -v90
    v_add_f32 v101, v101, v101
    v_mul_f32 v90, v101, v101
    v_mul_f32 v81, v100, v101
    v_fma_f32 v80, v100, v100, -v90
    v_add_f32 v81, v81, v81
    v_mul_f32 v90, v81, v81
    v_mul_f32 v83, v80, v81
    v_fma_f32 v82, v80, v80, -v90
    v_add_f32 v83, v83, v83
    v_mul_f32 v90, v83, v83
    v_mul_f32 v103, v82, v83
    v_fma_f32 v102, v82, v82, -v90
    v_add_f32 v103, v103, v103
    v_mul_f32 v90, v103, v103
    v_mul_f32 v105, v102, v103
    v_fma_f32 v104, v102, v102, -v90
    v_add_f32 v105, v105, v105
    v_cmp_lt_u32 vcc, 31, v0
    v_mov_b32 v84, 1.0
    v_mov_b32 v85, 0
    v_cndmask_b32 v86, v84, v100, vcc
    v_cndmask_b32 v87, v85, v101, vcc
    s_bitcmp1_b32 s4, 0
    s_cbranch_scc1 K1_PW1
    v_mov_b32 v80, 1.0
    v_mov_b32 v81, 0
K1_PW1:
    s_bitcmp1_b32 s4, 1
    s_cbranch_scc1 K1_PW2
    v_mov_b32 v82, 1.0
    v_mov_b32 v83, 0
K1_PW2:
    v_mul_f32 v90, v87, v81
    v_fma_f32 v88, v86, v80, -v90
    v_mul_f32 v90, v87, v80
    v_fma_f32 v89, v86, v81, v90
    v_mul_f32 v90, v89, v83
    v_fma_f32 v106, v88, v82, -v90
    v_mul_f32 v90, v89, v82
    v_fma_f32 v107, v88, v83, v90
    s_waitcnt lgkmcnt(0)
    s_barrier
    v_add_u32 v15, 0, v8
    ds_read_b128 a[0:3], v15
    v_add_u32 v127, 32768, v9
    ds_read_b128 v[64:67], v127
    ds_read_b128 v[68:71], v127 offset:8192
    v_xor_b32 v12, 32, v15
    ds_read_b128 a[4:7], v12
    v_xor_b32 v13, 32, v127
    ds_read_b128 v[72:75], v13
    ds_read_b128 v[76:79], v13 offset:8192
    v_xor_b32 v12, 64, v15
    ds_read_b128 a[8:11], v12
    v_xor_b32 v13, 64, v127
    ds_read_b128 v[80:83], v13
    ds_read_b128 v[84:87], v13 offset:8192
    s_waitcnt lgkmcnt(6)
    v_mfma_f32_32x32x16_bf16 v[16:31], a[0:3], v[64:67], 0
    v_mfma_f32_32x32x16_bf16 v[32:47], a[0:3], v[68:71], 0
    v_xor_b32 v12, 96, v15
    ds_read_b128 a[12:15], v12
    v_xor_b32 v13, 96, v127
    ds_read_b128 v[88:91], v13
    ds_read_b128 v[92:95], v13 offset:8192
    s_waitcnt lgkmcnt(6)
    v_mfma_f32_32x32x16_bf16 v[16:31], a[4:7], v[72:75], v[16:31]
    v_mfma_f32_32x32x16_bf16 v[32:47], a[4:7], v[76:79], v[32:47]
    v_xor_b32 v12, 128, v15
    ds_read_b128 a[16:19], v12
    v_xor_b32 v13, 128, v127
    ds_read_b128 v[64:67], v13
    ds_read_b128 v[68:71], v13 offset:8192
    s_waitcnt lgkmcnt(6)
    v_mfma_f32_32x32x16_bf16 v[16:31], a[8:11], v[80:83], v[16:31]
    v_mfma_f32_32x32x16_bf16 v[32:47], a[8:11], v[84:87], v[32:47]
    v_xor_b32 v12, 160, v15
    ds_read_b128 a[20:23], v12
    v_xor_b32 v13, 160, v127
    ds_read_b128 v[72:75], v13
    ds_read_b128 v[76:79], v13 offset:8192
    s_waitcnt lgkmcnt(6)
    v_mfma_f32_32x32x16_bf16 v[16:31], a[12:15], v[88:91], v[16:31]
    v_mfma_f32_32x32x16_bf16 v[32:47], a[12:15], v[92:95], v[32:47]
    v_xor_b32 v12, 192, v15
    ds_read_b128 a[24:27], v12
    v_xor_b32 v13, 192, v127
    ds_read_b128 v[80:83], v13
    ds_read_b128 v[84:87], v13 offset:8192
    s_waitcnt lgkmcnt(6)
    v_mfma_f32_32x32x16_bf16 v[16:31], a[16:19], v[64:67], v[16:31]
    v_mfma_f32_32x32x16_bf16 v[32:47], a[16:19], v[68:71], v[32:47]
    v_xor_b32 v12, 224, v15
    ds_read_b128 a[28:31], v12
    v_xor_b32 v13, 224, v127
    ds_read_b128 v[88:91], v13
    ds_read_b128 v[92:95], v13 offset:8192
    s_waitcnt lgkmcnt(6)
    v_mfma_f32_32x32x16_bf16 v[16:31], a[20:23], v[72:75], v[16:31]
    v_mfma_f32_32x32x16_bf16 v[32:47], a[20:23], v[76:79], v[32:47]
    s_waitcnt lgkmcnt(3)
    v_mfma_f32_32x32x16_bf16 v[16:31], a[24:27], v[80:83], v[16:31]
    v_mfma_f32_32x32x16_bf16 v[32:47], a[24:27], v[84:87], v[32:47]
    s_waitcnt lgkmcnt(0)
    v_mfma_f32_32x32x16_bf16 v[16:31], a[28:31], v[88:91], v[16:31]
    v_mfma_f32_32x32x16_bf16 v[32:47], a[28:31], v[92:95], v[32:47]
    s_waitcnt lgkmcnt(0)
    s_barrier
    v_add_u32 v15, 49152, v8
    ds_read_b128 a[32:35], v15
    v_add_u32 v127, 81920, v9
    ds_read_b128 v[64:67], v127
    ds_read_b128 v[68:71], v127 offset:8192
    v_xor_b32 v12, 32, v15
    ds_read_b128 a[36:39], v12
    v_xor_b32 v13, 32, v127
    ds_read_b128 v[72:75], v13
    ds_read_b128 v[76:79], v13 offset:8192
    v_xor_b32 v12, 64, v15
    ds_read_b128 a[40:43], v12
    v_xor_b32 v13, 64, v127
    ds_read_b128 v[80:83], v13
    ds_read_b128 v[84:87], v13 offset:8192
    s_waitcnt lgkmcnt(6)
    v_mfma_f32_32x32x16_bf16 v[16:31], a[32:35], v[64:67], v[16:31]
    v_mfma_f32_32x32x16_bf16 v[32:47], a[32:35], v[68:71], v[32:47]
    v_xor_b32 v12, 96, v15
    ds_read_b128 a[44:47], v12
    v_xor_b32 v13, 96, v127
    ds_read_b128 v[88:91], v13
    ds_read_b128 v[92:95], v13 offset:8192
    s_waitcnt lgkmcnt(6)
    v_mfma_f32_32x32x16_bf16 v[16:31], a[36:39], v[72:75], v[16:31]
    v_mfma_f32_32x32x16_bf16 v[32:47], a[36:39], v[76:79], v[32:47]
    v_xor_b32 v12, 128, v15
    ds_read_b128 a[48:51], v12
    v_xor_b32 v13, 128, v127
    ds_read_b128 v[64:67], v13
    ds_read_b128 v[68:71], v13 offset:8192
    s_waitcnt lgkmcnt(6)
    v_mfma_f32_32x32x16_bf16 v[16:31], a[40:43], v[80:83], v[16:31]
    v_mfma_f32_32x32x16_bf16 v[32:47], a[40:43], v[84:87], v[32:47]
    v_xor_b32 v12, 160, v15
    ds_read_b128 a[52:55], v12
    v_xor_b32 v13, 160, v127
    ds_read_b128 v[72:75], v13
    ds_read_b128 v[76:79], v13 offset:8192
    s_waitcnt lgkmcnt(6)
    v_mfma_f32_32x32x16_bf16 v[16:31], a[44:47], v[88:91], v[16:31]
    v_mfma_f32_32x32x16_bf16 v[32:47], a[44:47], v[92:95], v[32:47]
    v_xor_b32 v12, 192, v15
    ds_read_b128 a[56:59], v12
    v_xor_b32 v13, 192, v127
    ds_read_b128 v[80:83], v13
    ds_read_b128 v[84:87], v13 offset:8192
    s_waitcnt lgkmcnt(6)
    v_mfma_f32_32x32x16_bf16 v[16:31], a[48:51], v[64:67], v[16:31]
    v_mfma_f32_32x32x16_bf16 v[32:47], a[48:51], v[68:71], v[32:47]
    v_xor_b32 v12, 224, v15
    ds_read_b128 a[60:63], v12
    v_xor_b32 v13, 224, v127
    ds_read_b128 v[88:91], v13
    ds_read_b128 v[92:95], v13 offset:8192
    s_waitcnt lgkmcnt(6)
    v_mfma_f32_32x32x16_bf16 v[16:31], a[52:55], v[72:75], v[16:31]
    v_mfma_f32_32x32x16_bf16 v[32:47], a[52:55], v[76:79], v[32:47]
    s_waitcnt lgkmcnt(3)
    v_mfma_f32_32x32x16_bf16 v[16:31], a[56:59], v[80:83], v[16:31]
    v_mfma_f32_32x32x16_bf16 v[32:47], a[56:59], v[84:87], v[32:47]
    s_waitcnt lgkmcnt(0)
    v_mfma_f32_32x32x16_bf16 v[16:31], a[60:63], v[88:91], v[16:31]
    v_mfma_f32_32x32x16_bf16 v[32:47], a[60:63], v[92:95], v[32:47]
    s_waitcnt lgkmcnt(0)
    s_barrier
    v_mov_b32 v12, 0
    buffer_load_dword v112, v12, s[72:75], 0 offen sc1
    v_add_u32 v15, 98304, v8
    ds_read_b128 a[64:67], v15
    v_add_u32 v127, 131072, v9
    ds_read_b128 v[64:67], v127
    ds_read_b128 v[68:71], v127 offset:8192
    v_xor_b32 v12, 32, v15
    ds_read_b128 a[68:71], v12
    v_xor_b32 v13, 32, v127
    ds_read_b128 v[72:75], v13
    ds_read_b128 v[76:79], v13 offset:8192
    v_xor_b32 v12, 64, v15
    ds_read_b128 a[72:75], v12
    v_xor_b32 v13, 64, v127
    ds_read_b128 v[80:83], v13
    ds_read_b128 v[84:87], v13 offset:8192
    s_waitcnt lgkmcnt(6)
    v_mfma_f32_32x32x16_bf16 v[16:31], a[64:67], v[64:67], v[16:31]
    v_mfma_f32_32x32x16_bf16 v[32:47], a[64:67], v[68:71], v[32:47]
    v_xor_b32 v12, 96, v15
    ds_read_b128 a[76:79], v12
    v_xor_b32 v13, 96, v127
    ds_read_b128 v[88:91], v13
    ds_read_b128 v[92:95], v13 offset:8192
    s_waitcnt lgkmcnt(6)
    v_mfma_f32_32x32x16_bf16 v[16:31], a[68:71], v[72:75], v[16:31]
    v_mfma_f32_32x32x16_bf16 v[32:47], a[68:71], v[76:79], v[32:47]
    v_xor_b32 v12, 128, v15
    ds_read_b128 a[80:83], v12
    v_xor_b32 v13, 128, v127
    ds_read_b128 v[64:67], v13
    ds_read_b128 v[68:71], v13 offset:8192
    s_waitcnt lgkmcnt(6)
    v_mfma_f32_32x32x16_bf16 v[16:31], a[72:75], v[80:83], v[16:31]
    v_mfma_f32_32x32x16_bf16 v[32:47], a[72:75], v[84:87], v[32:47]
    v_xor_b32 v12, 160, v15
    ds_read_b128 a[84:87], v12
    v_xor_b32 v13, 160, v127
    ds_read_b128 v[72:75], v13
    ds_read_b128 v[76:79], v13 offset:8192
    s_waitcnt lgkmcnt(6)
    v_mfma_f32_32x32x16_bf16 v[16:31], a[76:79], v[88:91], v[16:31]
    v_mfma_f32_32x32x16_bf16 v[32:47], a[76:79], v[92:95], v[32:47]
    v_xor_b32 v12, 192, v15
    ds_read_b128 a[88:91], v12
    v_xor_b32 v13, 192, v127
    ds_read_b128 v[80:83], v13
    ds_read_b128 v[84:87], v13 offset:8192
    s_waitcnt lgkmcnt(6)
    v_mfma_f32_32x32x16_bf16 v[16:31], a[80:83], v[64:67], v[16:31]
    v_mfma_f32_32x32x16_bf16 v[32:47], a[80:83], v[68:71], v[32:47]
    v_xor_b32 v12, 224, v15
    ds_read_b128 a[92:95], v12
    v_xor_b32 v13, 224, v127
    ds_read_b128 v[88:91], v13
    ds_read_b128 v[92:95], v13 offset:8192
    s_waitcnt lgkmcnt(6)
    v_mfma_f32_32x32x16_bf16 v[16:31], a[84:87], v[72:75], v[16:31]
    v_mfma_f32_32x32x16_bf16 v[32:47], a[84:87], v[76:79], v[32:47]
    s_waitcnt lgkmcnt(3)
    v_mfma_f32_32x32x16_bf16 v[16:31], a[88:91], v[80:83], v[16:31]
    v_mfma_f32_32x32x16_bf16 v[32:47], a[88:91], v[84:87], v[32:47]
    s_waitcnt lgkmcnt(0)
    v_mfma_f32_32x32x16_bf16 v[16:31], a[92:95], v[88:91], v[16:31]
    v_mfma_f32_32x32x16_bf16 v[32:47], a[92:95], v[92:95], v[32:47]
    s_waitcnt lgkmcnt(0)
    s_barrier
    s_cmp_lg_u32 s4, 0
    s_cbranch_scc1 KA_NOZ
    v_mov_b32 v12, 134144
    v_mov_b32 v13, 0
    ds_write_b32 v12, v13
    ds_write_b32 v12, v13 offset:4
KA_NOZ:
    v_add_u32 v15, 0, v8
    ds_read_b128 a[96:99], v15
    v_add_u32 v127, 32768, v9
    ds_read_b128 v[64:67], v127
    ds_read_b128 v[68:71], v127 offset:8192
    v_xor_b32 v12, 32, v15
    ds_read_b128 a[100:103], v12
    v_xor_b32 v13, 32, v127
    ds_read_b128 v[72:75], v13
    ds_read_b128 v[76:79], v13 offset:8192
    v_xor_b32 v12, 64, v15
    ds_read_b128 a[104:107], v12
    v_xor_b32 v13, 64, v127
    ds_read_b128 v[80:83], v13
    ds_read_b128 v[84:87], v13 offset:8192
    s_waitcnt lgkmcnt(6)
    v_mfma_f32_32x32x16_bf16 v[16:31], a[96:99], v[64:67], v[16:31]
    v_mfma_f32_32x32x16_bf16 v[32:47], a[96:99], v[68:71], v[32:47]
    v_xor_b32 v12, 96, v15
    ds_read_b128 a[108:111], v12
    v_xor_b32 v13, 96, v127
    ds_read_b128 v[88:91], v13
    ds_read_b128 v[92:95], v13 offset:8192
    s_waitcnt lgkmcnt(6)
    v_mfma_f32_32x32x16_bf16 v[16:31], a[100:103], v[72:75], v[16:31]
    v_mfma_f32_32x32x16_bf16 v[32:47], a[100:103], v[76:79], v[32:47]
    v_xor_b32 v12, 128, v15
    ds_read_b128 a[112:115], v12
    v_xor_b32 v13, 128, v127
    ds_read_b128 v[64:67], v13
    ds_read_b128 v[68:71], v13 offset:8192
    s_waitcnt lgkmcnt(6)
    v_mfma_f32_32x32x16_bf16 v[16:31], a[104:107], v[80:83], v[16:31]
    v_mfma_f32_32x32x16_bf16 v[32:47], a[104:107], v[84:87], v[32:47]
    v_xor_b32 v12, 160, v15
    ds_read_b128 a[116:119], v12
    v_xor_b32 v13, 160, v127
    ds_read_b128 v[72:75], v13
    ds_read_b128 v[76:79], v13 offset:8192
    s_waitcnt lgkmcnt(6)
    v_mfma_f32_32x32x16_bf16 v[16:31], a[108:111], v[88:91], v[16:31]
    v_mfma_f32_32x32x16_bf16 v[32:47], a[108:111], v[92:95], v[32:47]
    v_xor_b32 v12, 192, v15
    ds_read_b128 a[120:123], v12
    v_xor_b32 v13, 192, v127
    ds_read_b128 v[80:83], v13
    ds_read_b128 v[84:87], v13 offset:8192
    s_waitcnt lgkmcnt(6)
    v_mfma_f32_32x32x16_bf16 v[16:31], a[112:115], v[64:67], v[16:31]
    v_mfma_f32_32x32x16_bf16 v[32:47], a[112:115], v[68:71], v[32:47]
    v_xor_b32 v12, 224, v15
    ds_read_b128 a[124:127], v12
    v_xor_b32 v13, 224, v127
    ds_read_b128 v[88:91], v13
    ds_read_b128 v[92:95], v13 offset:8192
    s_waitcnt lgkmcnt(6)
    v_mfma_f32_32x32x16_bf16 v[16:31], a[116:119], v[72:75], v[16:31]
    v_mfma_f32_32x32x16_bf16 v[32:47], a[116:119], v[76:79], v[32:47]
    s_waitcnt lgkmcnt(3)
    v_mfma_f32_32x32x16_bf16 v[16:31], a[120:123], v[80:83], v[16:31]
    v_mfma_f32_32x32x16_bf16 v[32:47], a[120:123], v[84:87], v[32:47]
    s_waitcnt lgkmcnt(0)
    v_mfma_f32_32x32x16_bf16 v[16:31], a[124:127], v[88:91], v[16:31]
    v_mfma_f32_32x32x16_bf16 v[32:47], a[124:127], v[92:95], v[32:47]
    s_nop 7
    s_nop 7
    v_fma_f32 v118, v96, v16, v18
    v_fma_f32 v119, v96, v17, v19
    v_fma_f32 v120, v96, v32, v34
    v_fma_f32 v121, v96, v33, v35
    v_fma_f32 v118, -v97, v32, v118
    v_fma_f32 v119, -v97, v33, v119
    v_fma_f32 v120, v97, v16, v120
    v_fma_f32 v121, v97, v17, v121
    v_fma_f32 v114, v96, v118, v20
    v_fma_f32 v115, v96, v119, v21
    v_fma_f32 v116, v96, v120, v36
    v_fma_f32 v117, v96, v121, v37
    v_fma_f32 v114, -v97, v120, v114
    v_fma_f32 v115, -v97, v121, v115
    v_fma_f32 v116, v97, v118, v116
    v_fma_f32 v117, v97, v119, v117
    v_fma_f32 v118, v96, v114, v22
    v_fma_f32 v119, v96, v115, v23
    v_fma_f32 v120, v96, v116, v38
    v_fma_f32 v121, v96, v117, v39
    v_fma_f32 v118, -v97, v116, v118
    v_fma_f32 v119, -v97, v117, v119
    v_fma_f32 v120, v97, v114, v120
    v_fma_f32 v121, v97, v115, v121
    v_fma_f32 v114, v96, v118, v24
    v_fma_f32 v115, v96, v119, v25
    v_fma_f32 v116, v96, v120, v40
    v_fma_f32 v117, v96, v121, v41
    v_fma_f32 v114, -v97, v120, v114
    v_fma_f32 v115, -v97, v121, v115
    v_fma_f32 v116, v97, v118, v116
    v_fma_f32 v117, v97, v119, v117
    v_fma_f32 v118, v96, v114, v26
    v_fma_f32 v119, v96, v115, v27
    v_fma_f32 v120, v96, v116, v42
    v_fma_f32 v121, v96, v117, v43
    v_fma_f32 v118, -v97, v116, v118
    v_fma_f32 v119, -v97, v117, v119
    v_fma_f32 v120, v97, v114, v120
    v_fma_f32 v121, v97, v115, v121
    v_fma_f32 v114, v96, v118, v28
    v_fma_f32 v115, v96, v119, v29
    v_fma_f32 v116, v96, v120, v44
    v_fma_f32 v117, v96, v121, v45
    v_fma_f32 v114, -v97, v120, v114
    v_fma_f32 v115, -v97, v121, v115
    v_fma_f32 v116, v97, v118, v116
    v_fma_f32 v117, v97, v119, v117
    v_fma_f32 v118, v96, v114, v30
    v_fma_f32 v119, v96, v115, v31
    v_fma_f32 v120, v96, v116, v46
    v_fma_f32 v121, v96, v117, v47
    v_fma_f32 v118, -v97, v116, v118
    v_fma_f32 v119, -v97, v117, v119
    v_fma_f32 v120, v97, v114, v120
    v_fma_f32 v121, v97, v115, v121
    v_mov_b32 v1, v118
    v_mov_b32 v2, v120
    v_fma_f32 v122, v110, v118, v119
    v_fma_f32 v123, v110, v120, v121
    v_fma_f32 v122, -v111, v120, v122
    v_fma_f32 v123, v111, v118, v123
    v_lshlrev_b32 v12, 3, v0
    s_lshl_b32 s76, s4, 9
    s_add_u32 s76, s76, 131072
    v_add_u32 v12, s76, v12
    ds_write_b64 v12, v[122:123]
    s_waitcnt lgkmcnt(0)
    s_barrier
    v_and_b32 v12, 31, v0
    v_lshlrev_b32 v12, 3, v12
    v_add_u32 v12, 131072, v12
    ds_read_b64 v[64:65], v12 offset:0
    ds_read_b64 v[66:67], v12 offset:256
    ds_read_b64 v[68:69], v12 offset:512
    ds_read_b64 v[70:71], v12 offset:768
    ds_read_b64 v[72:73], v12 offset:1024
    ds_read_b64 v[74:75], v12 offset:1280
    ds_read_b64 v[76:77], v12 offset:1536
    ds_read_b64 v[78:79], v12 offset:1792
    v_mov_b32 v108, 0
    v_mov_b32 v109, 0
    s_waitcnt vmcnt(0)
    v_readfirstlane_b32 s14, v112
    s_waitcnt lgkmcnt(0)
    s_cmp_eq_u32 s4, 0
    s_cbranch_scc0 KA_CQ_1
    v_mov_b32 v116, v64
    v_mov_b32 v117, v65
KA_CQ_1:
    v_fma_f32 v120, v100, v64, v66
    v_fma_f32 v121, v100, v65, v67
    v_fma_f32 v120, -v101, v65, v120
    v_fma_f32 v121, v101, v64, v121
    s_cmp_eq_u32 s4, 1
    s_cbranch_scc0 KA_CQ_2
    v_mov_b32 v108, v120
    v_mov_b32 v109, v121
KA_CQ_2:
    v_fma_f32 v118, v100, v120, v68
    v_fma_f32 v119, v100, v121, v69
    v_fma_f32 v118, -v101, v121, v118
    v_fma_f32 v119, v101, v120, v119
    s_cmp_eq_u32 s4, 1
    s_cbranch_scc0 KA_CQ_3
    v_mov_b32 v116, v118
    v_mov_b32 v117, v119
KA_CQ_3:
    v_fma_f32 v120, v100, v118, v70
    v_fma_f32 v121, v100, v119, v71
    v_fma_f32 v120, -v101, v119, v120
    v_fma_f32 v121, v101, v118, v121
    s_cmp_eq_u32 s4, 2
    s_cbranch_scc0 KA_CQ_4
    v_mov_b32 v108, v120
    v_mov_b32 v109, v121
KA_CQ_4:
    v_fma_f32 v118, v100, v120, v72
    v_fma_f32 v119, v100, v121, v73
    v_fma_f32 v118, -v101, v121, v118
    v_fma_f32 v119, v101, v120, v119
    s_cmp_eq_u32 s4, 2
    s_cbranch_scc0 KA_CQ_5
    v_mov_b32 v116, v118
    v_mov_b32 v117, v119
KA_CQ_5:
    v_fma_f32 v120, v100, v118, v74
    v_fma_f32 v121, v100, v119, v75
    v_fma_f32 v120, -v101, v119, v120
    v_fma_f32 v121, v101, v118, v121
    s_cmp_eq_u32 s4, 3
    s_cbranch_scc0 KA_CQ_6
    v_mov_b32 v108, v120
    v_mov_b32 v109, v121
KA_CQ_6:
    v_fma_f32 v118, v100, v120, v76
    v_fma_f32 v119, v100, v121, v77
    v_fma_f32 v118, -v101, v121, v118
    v_fma_f32 v119, v101, v120, v119
    s_cmp_eq_u32 s4, 3
    s_cbranch_scc0 KA_CQ_7
    v_mov_b32 v116, v118
    v_mov_b32 v117, v119
KA_CQ_7:
    v_fma_f32 v120, v100, v118, v78
    v_fma_f32 v121, v100, v119, v79
    v_fma_f32 v120, -v101, v119, v120
    v_fma_f32 v121, v101, v118, v121
    s_mov_b32 s81, 0
    s_cmp_lg_u32 s14, 0
    s_cbranch_scc1 KA_NONCE_OK
KA_NONCE:
    v_mov_b32 v12, 0
    buffer_load_dword v112, v12, s[72:75], 0 offen sc1
    s_waitcnt vmcnt(0)
    v_readfirstlane_b32 s14, v112
    s_add_u32 s81, s81, 1
    s_cmp_gt_u32 s81, 300000
    s_cbranch_scc1 KA_NONCE_OK
    s_cmp_eq_u32 s14, 0
    s_cbranch_scc1 KA_NONCE
KA_NONCE_OK:
    s_not_b32 s15, s14
    v_mov_b32 v80, v120
    v_mov_b32 v81, s14
    v_mov_b32 v82, v121
    v_mov_b32 v83, s15
    s_lshl_b32 s76, s4, 3
    s_lshl_b32 s77, 0xff, s76
    s_lshl_b32 s78, s5, 9
    s_mov_b32 exec_lo, s77
    s_mov_b32 exec_hi, 0
    buffer_store_dwordx4 v[80:83], v14, s[68:71], s78 offen sc1
    s_mov_b64 exec, -1
    v_cmp_lt_u32 vcc, 31, v0
    s_nop 1
    v_cndmask_b32 v108, v108, v116, vcc
    v_cndmask_b32 v109, v109, v117, vcc
    v_and_b32 v13, 31, v0
    v_lshlrev_b32 v13, 4, v13
    v_lshrrev_b32 v15, 5, v0
    v_lshlrev_b32 v15, 9, v15
    v_sub_u32 v13, v13, v15
    s_lshl_b32 s76, s5, 9
    s_sub_u32 s76, s76, 512
    v_add_u32 v3, s76, v13
    v_add_u32 v4, -1024, v3
    v_add_u32 v5, -2048, v3
    v_add_u32 v6, -3072, v3
    v_add_u32 v7, -4096, v3
    v_add_u32 v112, -5120, v3
    v_add_u32 v100, -6144, v3
    v_add_u32 v101, -7168, v3
    v_mov_b32 v113, v10
    s_cmp_gt_u32 s5, 0
    s_cselect_b32 s44, -1, 0
    s_cmp_gt_u32 s5, 1
    s_cselect_b32 s45, -1, 0
    s_cmp_gt_u32 s5, 2
    s_cselect_b32 s46, -1, 0
    s_cmp_gt_u32 s5, 3
    s_cselect_b32 s47, -1, 0
    s_cmp_gt_u32 s5, 4
    s_cselect_b32 s48, -1, 0
    s_cmp_gt_u32 s5, 5
    s_cselect_b32 s49, -1, 0
    s_cmp_gt_u32 s5, 6
    s_cselect_b32 s50, -1, 0
    s_cmp_gt_u32 s5, 7
    s_cselect_b32 s51, -1, 0
    s_cmp_gt_u32 s5, 8
    s_cselect_b32 s52, -1, 0
    s_cmp_gt_u32 s5, 9
    s_cselect_b32 s53, -1, 0
    s_cmp_gt_u32 s5, 10
    s_cselect_b32 s54, -1, 0
    s_cmp_gt_u32 s5, 11
    s_cselect_b32 s55, -1, 0
    s_cmp_gt_u32 s5, 12
    s_cselect_b32 s60, -1, 0
    s_cmp_gt_u32 s5, 13
    s_cselect_b32 s61, -1, 0
    s_cmp_gt_u32 s5, 14
    s_cselect_b32 s62, -1, 0
    s_cmp_gt_u32 s5, 15
    s_cselect_b32 s63, -1, 0
    s_mul_i32 s76, s4, 4608
    s_add_u32 s76, s76, 32768
    s_cmp_eq_u32 s4, 3
    s_cselect_b32 s76, 147456, s76
    v_lshrrev_b32 v13, 5, v0
    v_lshlrev_b32 v13, 3, v13
    v_bfe_u32 v15, v0, 2, 2
    v_add_u32 v13, v13, v15
    v_mul_u32_u24 v13, 72, v13
    v_bfe_u32 v15, v0, 4, 1
    v_lshl_add_u32 v13, v15, 5, v13
    v_and_b32 v15, 3, v0
    v_lshl_add_u32 v13, v15, 3, v13
    v_add_u32 v13, s76, v13
    v_and_b32 v12, 31, v0
    v_mul_u32_u24 v12, 72, v12
    v_lshrrev_b32 v15, 5, v0
    v_lshl_add_u32 v15, v15, 3, v12
    v_add_u32 v15, s76, v15
    s_setprio 0
    s_cmp_lg_u32 s8, 0
    s_cbranch_scc1 KA_NOB5
    s_waitcnt lgkmcnt(0)
    s_barrier
KA_NOB5:
    buffer_load_dwordx4 v[80:83], v3, s[68:71], 0 offen sc1
    buffer_load_dwordx4 v[84:87], v4, s[68:71], 0 offen sc1
    buffer_load_dwordx4 v[88:91], v5, s[68:71], 0 offen sc1
    buffer_load_dwordx4 v[92:95], v6, s[68:71], 0 offen sc1
    buffer_load_dwordx4 v[116:119], v7, s[68:71], 0 offen sc1
    buffer_load_dwordx4 v[120:123], v112, s[68:71], 0 offen sc1
    buffer_load_dwordx4 v[124:127], v100, s[68:71], 0 offen sc1
    buffer_load_dwordx4 v[8:11], v101, s[68:71], 0 offen sc1
    s_cmp_lg_u32 s8, 0
    s_cbranch_scc1 KA_TB
    s_setprio 2
    v_add_u32 v12, 0x10000, v113
    ds_read_b64_tr_b16 v[64:65], v12 offset:32768
    ds_read_b64_tr_b16 v[66:67], v12 offset:33280
    ds_read_b64_tr_b16 v[68:69], v12 offset:34816
    ds_read_b64_tr_b16 v[70:71], v12 offset:35328
    ds_read_b64_tr_b16 v[72:73], v12 offset:36864
    ds_read_b64_tr_b16 v[74:75], v12 offset:37376
    s_waitcnt lgkmcnt(4)
    v_mfma_f32_32x32x16_bf16 v[48:63], v[64:67], a[0:3], 0
    ds_read_b64_tr_b16 v[76:77], v12 offset:38912
    ds_read_b64_tr_b16 v[78:79], v12 offset:39424
    s_waitcnt lgkmcnt(4)
    v_mfma_f32_32x32x16_bf16 v[48:63], v[68:71], a[4:7], v[48:63]
    ds_read_b64_tr_b16 v[64:65], v12 offset:40960
    ds_read_b64_tr_b16 v[66:67], v12 offset:41472
    s_waitcnt lgkmcnt(4)
    v_mfma_f32_32x32x16_bf16 v[48:63], v[72:75], a[8:11], v[48:63]
    ds_read_b64_tr_b16 v[68:69], v12 offset:43008
    ds_read_b64_tr_b16 v[70:71], v12 offset:43520
    s_waitcnt lgkmcnt(4)
    v_mfma_f32_32x32x16_bf16 v[48:63], v[76:79], a[12:15], v[48:63]
    ds_read_b64_tr_b16 v[72:73], v12 offset:45056
    ds_read_b64_tr_b16 v[74:75], v12 offset:45568
    s_waitcnt lgkmcnt(4)
    v_mfma_f32_32x32x16_bf16 v[48:63], v[64:67], a[16:19], v[48:63]
    ds_read_b64_tr_b16 v[76:77], v12 offset:47104
    ds_read_b64_tr_b16 v[78:79], v12 offset:47616
    s_waitcnt lgkmcnt(4)
    v_mfma_f32_32x32x16_bf16 v[48:63], v[68:71], a[20:23], v[48:63]
    ds_read_b64_tr_b16 v[64:65], v12 offset:49152
    ds_read_b64_tr_b16 v[66:67], v12 offset:49664
    s_waitcnt lgkmcnt(4)
    v_mfma_f32_32x32x16_bf16 v[48:63], v[72:75], a[24:27], v[48:63]
    ds_read_b64_tr_b16 v[68:69], v12 offset:51200
    ds_read_b64_tr_b16 v[70:71], v12 offset:51712
    s_waitcnt lgkmcnt(4)
    v_mfma_f32_32x32x16_bf16 v[48:63], v[76:79], a[28:31], v[48:63]
    ds_read_b64_tr_b16 v[72:73], v12 offset:53248
    ds_read_b64_tr_b16 v[74:75], v12 offset:53760
    s_waitcnt lgkmcnt(4)
    v_mfma_f32_32x32x16_bf16 v[48:63], v[64:67], a[32:35], v[48:63]
    ds_read_b64_tr_b16 v[76:77], v12 offset:55296
    ds_read_b64_tr_b16 v[78:79], v12 offset:55808
    s_waitcnt lgkmcnt(4)
    v_mfma_f32_32x32x16_bf16 v[48:63], v[68:71], a[36:39], v[48:63]
    ds_read_b64_tr_b16 v[64:65], v12 offset:57344
    ds_read_b64_tr_b16 v[66:67], v12 offset:57856
    s_waitcnt lgkmcnt(4)
    v_mfma_f32_32x32x16_bf16 v[48:63], v[72:75], a[40:43], v[48:63]
    ds_read_b64_tr_b16 v[68:69], v12 offset:59392
    ds_read_b64_tr_b16 v[70:71], v12 offset:59904
    s_waitcnt lgkmcnt(4)
    v_mfma_f32_32x32x16_bf16 v[48:63], v[76:79], a[44:47], v[48:63]
    ds_read_b64_tr_b16 v[72:73], v12 offset:61440
    ds_read_b64_tr_b16 v[74:75], v12 offset:61952
    s_waitcnt lgkmcnt(4)
    v_mfma_f32_32x32x16_bf16 v[48:63], v[64:67], a[48:51], v[48:63]
    ds_read_b64_tr_b16 v[76:77], v12 offset:63488
    ds_read_b64_tr_b16 v[78:79], v12 offset:64000
    s_waitcnt lgkmcnt(4)
    v_mfma_f32_32x32x16_bf16 v[48:63], v[68:71], a[52:55], v[48:63]
    ds_read_b64_tr_b16 v[64:65], v113 offset:0
    ds_read_b64_tr_b16 v[66:67], v113 offset:512
    s_waitcnt lgkmcnt(4)
    v_mfma_f32_32x32x16_bf16 v[48:63], v[72:75], a[56:59], v[48:63]
    ds_read_b64_tr_b16 v[68:69], v113 offset:2048
    ds_read_b64_tr_b16 v[70:71], v113 offset:2560
    s_waitcnt lgkmcnt(4)
    v_mfma_f32_32x32x16_bf16 v[48:63], v[76:79], a[60:63], v[48:63]
    ds_read_b64_tr_b16 v[72:73], v113 offset:4096
    ds_read_b64_tr_b16 v[74:75], v113 offset:4608
    s_waitcnt lgkmcnt(4)
    v_mfma_f32_32x32x16_bf16 v[48:63], v[64:67], a[64:67], v[48:63]
    ds_read_b64_tr_b16 v[76:77], v113 offset:6144
    ds_read_b64_tr_b16 v[78:79], v113 offset:6656
    s_waitcnt lgkmcnt(4)
    v_mfma_f32_32x32x16_bf16 v[48:63], v[68:71], a[68:71], v[48:63]
    ds_read_b64_tr_b16 v[64:65], v113 offset:8192
    ds_read_b64_tr_b16 v[66:67], v113 offset:8704
    s_waitcnt lgkmcnt(4)
    v_mfma_f32_32x32x16_bf16 v[48:63], v[72:75], a[72:75], v[48:63]
    ds_read_b64_tr_b16 v[68:69], v113 offset:10240
    ds_read_b64_tr_b16 v[70:71], v113 offset:10752
    s_waitcnt lgkmcnt(4)
    v_mfma_f32_32x32x16_bf16 v[48:63], v[76:79], a[76:79], v[48:63]
    ds_read_b64_tr_b16 v[72:73], v113 offset:12288
    ds_read_b64_tr_b16 v[74:75], v113 offset:12800
    s_waitcnt lgkmcnt(4)
    v_mfma_f32_32x32x16_bf16 v[48:63], v[64:67], a[80:83], v[48:63]
    ds_read_b64_tr_b16 v[76:77], v113 offset:14336
    ds_read_b64_tr_b16 v[78:79], v113 offset:14848
    s_waitcnt lgkmcnt(4)
    v_mfma_f32_32x32x16_bf16 v[48:63], v[68:71], a[84:87], v[48:63]
    ds_read_b64_tr_b16 v[64:65], v113 offset:16384
    ds_read_b64_tr_b16 v[66:67], v113 offset:16896
    s_waitcnt lgkmcnt(4)
    v_mfma_f32_32x32x16_bf16 v[48:63], v[72:75], a[88:91], v[48:63]
    ds_read_b64_tr_b16 v[68:69], v113 offset:18432
    ds_read_b64_tr_b16 v[70:71], v113 offset:18944
    s_waitcnt lgkmcnt(4)
    v_mfma_f32_32x32x16_bf16 v[48:63], v[76:79], a[92:95], v[48:63]
    ds_read_b64_tr_b16 v[72:73], v113 offset:20480
    ds_read_b64_tr_b16 v[74:75], v113 offset:20992
    s_waitcnt lgkmcnt(4)
    v_mfma_f32_32x32x16_bf16 v[48:63], v[64:67], a[96:99], v[48:63]
    ds_read_b64_tr_b16 v[76:77], v113 offset:22528
    ds_read_b64_tr_b16 v[78:79], v113 offset:23040
    s_waitcnt lgkmcnt(4)
    v_mfma_f32_32x32x16_bf16 v[48:63], v[68:71], a[100:103], v[48:63]
    ds_read_b64_tr_b16 v[64:65], v113 offset:24576
    ds_read_b64_tr_b16 v[66:67], v113 offset:25088
    s_waitcnt lgkmcnt(4)
    v_mfma_f32_32x32x16_bf16 v[48:63], v[72:75], a[104:107], v[48:63]
    ds_read_b64_tr_b16 v[68:69], v113 offset:26624
    ds_read_b64_tr_b16 v[70:71], v113 offset:27136
    s_waitcnt lgkmcnt(4)
    v_mfma_f32_32x32x16_bf16 v[48:63], v[76:79], a[108:111], v[48:63]
    ds_read_b64_tr_b16 v[72:73], v113 offset:28672
    ds_read_b64_tr_b16 v[74:75], v113 offset:29184
    s_waitcnt lgkmcnt(4)
    v_mfma_f32_32x32x16_bf16 v[48:63], v[64:67], a[112:115], v[48:63]
    ds_read_b64_tr_b16 v[76:77], v113 offset:30720
    ds_read_b64_tr_b16 v[78:79], v113 offset:31232
    s_waitcnt lgkmcnt(4)
    v_mfma_f32_32x32x16_bf16 v[48:63], v[68:71], a[116:119], v[48:63]
    s_waitcnt lgkmcnt(2)
    v_mfma_f32_32x32x16_bf16 v[48:63], v[72:75], a[120:123], v[48:63]
    s_waitcnt lgkmcnt(0)
    v_mfma_f32_32x32x16_bf16 v[48:63], v[76:79], a[124:127], v[48:63]
    s_setprio 2
    s_branch KA_J1
KA_TB:
KA_J1:
    s_waitcnt vmcnt(0)
    s_mov_b32 s81, 0
    s_mov_b64 s[22:23], 0
    v_cmp_ne_u32 s[24:25], s14, v81
    v_cmp_ne_u32 s[26:27], s15, v83
    v_cmp_ne_u32 s[28:29], s14, v85
    v_cmp_ne_u32 s[30:31], s15, v87
    s_or_b64 s[24:25], s[24:25], s[26:27]
    s_and_b64 s[24:25], s[24:25], s[44:45]
    s_or_b64 s[22:23], s[22:23], s[24:25]
    v_cmp_ne_u32 s[24:25], s14, v89
    v_cmp_ne_u32 s[26:27], s15, v91
    s_or_b64 s[28:29], s[28:29], s[30:31]
    s_and_b64 s[28:29], s[28:29], s[46:47]
    s_or_b64 s[22:23], s[22:23], s[28:29]
    v_cmp_ne_u32 s[28:29], s14, v93
    v_cmp_ne_u32 s[30:31], s15, v95
    s_or_b64 s[24:25], s[24:25], s[26:27]
    s_and_b64 s[24:25], s[24:25], s[48:49]
    s_or_b64 s[22:23], s[22:23], s[24:25]
    v_cmp_ne_u32 s[24:25], s14, v117
    v_cmp_ne_u32 s[26:27], s15, v119
    s_or_b64 s[28:29], s[28:29], s[30:31]
    s_and_b64 s[28:29], s[28:29], s[50:51]
    s_or_b64 s[22:23], s[22:23], s[28:29]
    v_cmp_ne_u32 s[28:29], s14, v121
    v_cmp_ne_u32 s[30:31], s15, v123
    s_or_b64 s[24:25], s[24:25], s[26:27]
    s_and_b64 s[24:25], s[24:25], s[52:53]
    s_or_b64 s[22:23], s[22:23], s[24:25]
    v_cmp_ne_u32 s[24:25], s14, v125
    v_cmp_ne_u32 s[26:27], s15, v127
    s_or_b64 s[28:29], s[28:29], s[30:31]
    s_and_b64 s[28:29], s[28:29], s[54:55]
    s_or_b64 s[22:23], s[22:23], s[28:29]
    v_cmp_ne_u32 s[28:29], s14, v9
    v_cmp_ne_u32 s[30:31], s15, v11
    s_or_b64 s[24:25], s[24:25], s[26:27]
    s_and_b64 s[24:25], s[24:25], s[60:61]
    s_or_b64 s[22:23], s[22:23], s[24:25]
    s_nop 2
    s_or_b64 s[28:29], s[28:29], s[30:31]
    s_and_b64 s[28:29], s[28:29], s[62:63]
    s_or_b64 s[22:23], s[22:23], s[28:29]
    s_cmp_lg_u64 s[22:23], 0
    s_cbranch_scc0 KA_LBOK1
    buffer_load_dwordx4 v[80:83], v3, s[68:71], 0 offen sc1
    buffer_load_dwordx4 v[84:87], v4, s[68:71], 0 offen sc1
    buffer_load_dwordx4 v[88:91], v5, s[68:71], 0 offen sc1
    buffer_load_dwordx4 v[92:95], v6, s[68:71], 0 offen sc1
    buffer_load_dwordx4 v[116:119], v7, s[68:71], 0 offen sc1
    buffer_load_dwordx4 v[120:123], v112, s[68:71], 0 offen sc1
    buffer_load_dwordx4 v[124:127], v100, s[68:71], 0 offen sc1
    buffer_load_dwordx4 v[8:11], v101, s[68:71], 0 offen sc1
    s_mov_b32 s81, 1
KA_LBOK1:
    s_cmp_lg_u32 s8, 0
    s_cbranch_scc1 KA_NOEPI
    s_lshr_b32 s76, s7, 5
    s_add_u32 s76, s76, 4
    s_lshl_b32 s76, s76, 10
    s_add_u32 s76, s76, s80
    v_cvt_pk_bf16_f32 v72, v48, v49
    v_cvt_pk_bf16_f32 v73, v50, v51
    v_cvt_pk_bf16_f32 v74, v52, v53
    v_cvt_pk_bf16_f32 v75, v54, v55
    v_lshlrev_b32 v48, 16, v72
    v_and_b32 v49, s20, v72
    v_lshlrev_b32 v50, 16, v73
    v_and_b32 v51, s20, v73
    v_lshlrev_b32 v52, 16, v74
    v_and_b32 v53, s20, v74
    v_lshlrev_b32 v54, 16, v75
    v_and_b32 v55, s20, v75
    v_mul_f32 v64, s16, v48
    v_mul_f32 v65, s16, v49
    v_mul_f32 v66, s16, v50
    v_mul_f32 v67, s16, v51
    v_mul_f32 v68, s16, v52
    v_mul_f32 v69, s16, v53
    v_mul_f32 v70, s16, v54
    v_mul_f32 v71, s16, v55
    v_exp_f32 v64, v64
    v_exp_f32 v65, v65
    v_exp_f32 v66, v66
    v_exp_f32 v67, v67
    v_exp_f32 v68, v68
    v_exp_f32 v69, v69
    v_exp_f32 v70, v70
    v_exp_f32 v71, v71
    v_add_f32 v64, 1.0, v64
    v_add_f32 v65, 1.0, v65
    v_add_f32 v66, 1.0, v66
    v_add_f32 v67, 1.0, v67
    v_add_f32 v68, 1.0, v68
    v_add_f32 v69, 1.0, v69
    v_add_f32 v70, 1.0, v70
    v_add_f32 v71, 1.0, v71
    v_rcp_f32 v64, v64
    v_rcp_f32 v65, v65
    v_rcp_f32 v66, v66
    v_rcp_f32 v67, v67
    v_rcp_f32 v68, v68
    v_rcp_f32 v69, v69
    v_rcp_f32 v70, v70
    v_rcp_f32 v71, v71
    v_mul_f32 v48, v48, v64
    v_mul_f32 v49, v49, v65
    v_mul_f32 v50, v50, v66
    v_mul_f32 v51, v51, v67
    v_mul_f32 v52, v52, v68
    v_mul_f32 v53, v53, v69
    v_mul_f32 v54, v54, v70
    v_mul_f32 v55, v55, v71
    v_cvt_pk_bf16_f32 v48, v48, v49
    v_cvt_pk_bf16_f32 v49, v50, v51
    v_cvt_pk_bf16_f32 v50, v52, v53
    v_cvt_pk_bf16_f32 v51, v54, v55
    buffer_store_dwordx4 v[48:51], v14, s[56:59], s76 offen offset:0 sc1
    v_cvt_pk_bf16_f32 v72, v56, v57
    v_cvt_pk_bf16_f32 v73, v58, v59
    v_cvt_pk_bf16_f32 v74, v60, v61
    v_cvt_pk_bf16_f32 v75, v62, v63
    v_lshlrev_b32 v56, 16, v72
    v_and_b32 v57, s20, v72
    v_lshlrev_b32 v58, 16, v73
    v_and_b32 v59, s20, v73
    v_lshlrev_b32 v60, 16, v74
    v_and_b32 v61, s20, v74
    v_lshlrev_b32 v62, 16, v75
    v_and_b32 v63, s20, v75
    v_mul_f32 v64, s16, v56
    v_mul_f32 v65, s16, v57
    v_mul_f32 v66, s16, v58
    v_mul_f32 v67, s16, v59
    v_mul_f32 v68, s16, v60
    v_mul_f32 v69, s16, v61
    v_mul_f32 v70, s16, v62
    v_mul_f32 v71, s16, v63
    v_exp_f32 v64, v64
    v_exp_f32 v65, v65
    v_exp_f32 v66, v66
    v_exp_f32 v67, v67
    v_exp_f32 v68, v68
    v_exp_f32 v69, v69
    v_exp_f32 v70, v70
    v_exp_f32 v71, v71
    v_add_f32 v64, 1.0, v64
    v_add_f32 v65, 1.0, v65
    v_add_f32 v66, 1.0, v66
    v_add_f32 v67, 1.0, v67
    v_add_f32 v68, 1.0, v68
    v_add_f32 v69, 1.0, v69
    v_add_f32 v70, 1.0, v70
    v_add_f32 v71, 1.0, v71
    v_rcp_f32 v64, v64
    v_rcp_f32 v65, v65
    v_rcp_f32 v66, v66
    v_rcp_f32 v67, v67
    v_rcp_f32 v68, v68
    v_rcp_f32 v69, v69
    v_rcp_f32 v70, v70
    v_rcp_f32 v71, v71
    v_mul_f32 v56, v56, v64
    v_mul_f32 v57, v57, v65
    v_mul_f32 v58, v58, v66
    v_mul_f32 v59, v59, v67
    v_mul_f32 v60, v60, v68
    v_mul_f32 v61, v61, v69
    v_mul_f32 v62, v62, v70
    v_mul_f32 v63, v63, v71
    v_cvt_pk_bf16_f32 v56, v56, v57
    v_cvt_pk_bf16_f32 v57, v58, v59
    v_cvt_pk_bf16_f32 v58, v60, v61
    v_cvt_pk_bf16_f32 v59, v62, v63
    buffer_store_dwordx4 v[56:59], v14, s[56:59], s76 offen offset:1024 sc1
KA_NOEPI:
    s_cmp_eq_u32 s81, 0
    s_cbranch_scc1 KA_LBOK
KA_LB:
    s_waitcnt vmcnt(0)
    s_add_u32 s81, s81, 1
    s_cmp_gt_u32 s81, 300000
    s_cbranch_scc1 KA_LBOK
    s_mov_b64 s[22:23], 0
    v_cmp_ne_u32 s[24:25], s14, v81
    v_cmp_ne_u32 s[26:27], s15, v83
    v_cmp_ne_u32 s[28:29], s14, v85
    v_cmp_ne_u32 s[30:31], s15, v87
    s_or_b64 s[24:25], s[24:25], s[26:27]
    s_and_b64 s[24:25], s[24:25], s[44:45]
    s_or_b64 s[22:23], s[22:23], s[24:25]
    v_cmp_ne_u32 s[24:25], s14, v89
    v_cmp_ne_u32 s[26:27], s15, v91
    s_or_b64 s[28:29], s[28:29], s[30:31]
    s_and_b64 s[28:29], s[28:29], s[46:47]
    s_or_b64 s[22:23], s[22:23], s[28:29]
    v_cmp_ne_u32 s[28:29], s14, v93
    v_cmp_ne_u32 s[30:31], s15, v95
    s_or_b64 s[24:25], s[24:25], s[26:27]
    s_and_b64 s[24:25], s[24:25], s[48:49]
    s_or_b64 s[22:23], s[22:23], s[24:25]
    v_cmp_ne_u32 s[24:25], s14, v117
    v_cmp_ne_u32 s[26:27], s15, v119
    s_or_b64 s[28:29], s[28:29], s[30:31]
    s_and_b64 s[28:29], s[28:29], s[50:51]
    s_or_b64 s[22:23], s[22:23], s[28:29]
    v_cmp_ne_u32 s[28:29], s14, v121
    v_cmp_ne_u32 s[30:31], s15, v123
    s_or_b64 s[24:25], s[24:25], s[26:27]
    s_and_b64 s[24:25], s[24:25], s[52:53]
    s_or_b64 s[22:23], s[22:23], s[24:25]
    v_cmp_ne_u32 s[24:25], s14, v125
    v_cmp_ne_u32 s[26:27], s15, v127
    s_or_b64 s[28:29], s[28:29], s[30:31]
    s_and_b64 s[28:29], s[28:29], s[54:55]
    s_or_b64 s[22:23], s[22:23], s[28:29]
    v_cmp_ne_u32 s[28:29], s14, v9
    v_cmp_ne_u32 s[30:31], s15, v11
    s_or_b64 s[24:25], s[24:25], s[26:27]
    s_and_b64 s[24:25], s[24:25], s[60:61]
    s_or_b64 s[22:23], s[22:23], s[24:25]
    s_nop 2
    s_or_b64 s[28:29], s[28:29], s[30:31]
    s_and_b64 s[28:29], s[28:29], s[62:63]
    s_or_b64 s[22:23], s[22:23], s[28:29]
    s_cmp_lg_u64 s[22:23], 0
    s_cbranch_scc0 KA_LBOK
    buffer_load_dwordx4 v[80:83], v3, s[68:71], 0 offen sc1
    buffer_load_dwordx4 v[84:87], v4, s[68:71], 0 offen sc1
    buffer_load_dwordx4 v[88:91], v5, s[68:71], 0 offen sc1
    buffer_load_dwordx4 v[92:95], v6, s[68:71], 0 offen sc1
    buffer_load_dwordx4 v[116:119], v7, s[68:71], 0 offen sc1
    buffer_load_dwordx4 v[120:123], v112, s[68:71], 0 offen sc1
    buffer_load_dwordx4 v[124:127], v100, s[68:71], 0 offen sc1
    buffer_load_dwordx4 v[8:11], v101, s[68:71], 0 offen sc1
    s_branch KA_LB
KA_LBOK:
    v_fma_f32 v114, v104, v8, v124
    v_fma_f32 v115, v104, v10, v126
    v_fma_f32 v114, -v105, v10, v114
    v_fma_f32 v115, v105, v8, v115
    v_fma_f32 v76, v104, v114, v120
    v_fma_f32 v77, v104, v115, v122
    v_fma_f32 v76, -v105, v115, v76
    v_fma_f32 v77, v105, v114, v77
    v_fma_f32 v114, v104, v76, v116
    v_fma_f32 v115, v104, v77, v118
    v_fma_f32 v114, -v105, v77, v114
    v_fma_f32 v115, v105, v76, v115
    v_fma_f32 v76, v104, v114, v92
    v_fma_f32 v77, v104, v115, v94
    v_fma_f32 v76, -v105, v115, v76
    v_fma_f32 v77, v105, v114, v77
    v_fma_f32 v114, v104, v76, v88
    v_fma_f32 v115, v104, v77, v90
    v_fma_f32 v114, -v105, v77, v114
    v_fma_f32 v115, v105, v76, v115
    v_fma_f32 v76, v104, v114, v84
    v_fma_f32 v77, v104, v115, v86
    v_fma_f32 v76, -v105, v115, v76
    v_fma_f32 v77, v105, v114, v77
    v_fma_f32 v114, v104, v76, v80
    v_fma_f32 v115, v104, v77, v82
    v_fma_f32 v114, -v105, v77, v114
    v_fma_f32 v115, v105, v76, v115
    v_mul_f32 v66, v115, v103
    v_fma_f32 v68, v114, v102, -v66
    v_mul_f32 v66, v115, v102
    v_fma_f32 v69, v114, v103, v66
    v_cmp_lt_u32 vcc, 31, v0
    s_nop 1
    v_cndmask_b32 v64, v114, v68, vcc
    v_cndmask_b32 v65, v115, v69, vcc
    v_mov_b32 v66, v64
    v_mov_b32 v67, v65
    s_nop 1
    v_permlane32_swap_b32 v66, v64
    v_permlane32_swap_b32 v67, v65
    s_nop 1
    v_add_f32 v64, v64, v66
    v_add_f32 v65, v65, v67
    v_fma_f32 v72, v106, v64, v108
    v_fma_f32 v74, v106, v65, v109
    v_fma_f32 v72, -v107, v65, v72
    v_fma_f32 v74, v107, v64, v74
    v_fma_f32 v73, v110, v72, v1
    v_fma_f32 v75, v110, v74, v2
    v_fma_f32 v73, -v111, v74, v73
    v_fma_f32 v75, v111, v72, v75
    v_pk_fma_f32 v[66:67], v[96:97], v[72:73], v[16:17] op_sel:[0,0,0] op_sel_hi:[0,1,1]
    v_pk_fma_f32 v[68:69], v[96:97], v[74:75], v[32:33] op_sel:[0,0,0] op_sel_hi:[0,1,1]
    v_pk_fma_f32 v[16:17], v[96:97], v[74:75], v[66:67] op_sel:[1,0,0] op_sel_hi:[1,1,1] neg_lo:[1,0,0] neg_hi:[1,0,0]
    v_pk_fma_f32 v[32:33], v[96:97], v[72:73], v[68:69] op_sel:[1,0,0] op_sel_hi:[1,1,1]
    v_pk_fma_f32 v[66:67], v[96:97], v[16:17], v[18:19] op_sel:[0,0,0] op_sel_hi:[0,1,1]
    v_pk_fma_f32 v[68:69], v[96:97], v[32:33], v[34:35] op_sel:[0,0,0] op_sel_hi:[0,1,1]
    v_pk_fma_f32 v[18:19], v[96:97], v[32:33], v[66:67] op_sel:[1,0,0] op_sel_hi:[1,1,1] neg_lo:[1,0,0] neg_hi:[1,0,0]
    v_pk_fma_f32 v[34:35], v[96:97], v[16:17], v[68:69] op_sel:[1,0,0] op_sel_hi:[1,1,1]
    v_pk_fma_f32 v[66:67], v[96:97], v[18:19], v[20:21] op_sel:[0,0,0] op_sel_hi:[0,1,1]
    v_pk_fma_f32 v[68:69], v[96:97], v[34:35], v[36:37] op_sel:[0,0,0] op_sel_hi:[0,1,1]
    v_pk_fma_f32 v[20:21], v[96:97], v[34:35], v[66:67] op_sel:[1,0,0] op_sel_hi:[1,1,1] neg_lo:[1,0,0] neg_hi:[1,0,0]
    v_pk_fma_f32 v[36:37], v[96:97], v[18:19], v[68:69] op_sel:[1,0,0] op_sel_hi:[1,1,1]
    v_pk_fma_f32 v[66:67], v[96:97], v[20:21], v[22:23] op_sel:[0,0,0] op_sel_hi:[0,1,1]
    v_pk_fma_f32 v[68:69], v[96:97], v[36:37], v[38:39] op_sel:[0,0,0] op_sel_hi:[0,1,1]
    v_pk_fma_f32 v[22:23], v[96:97], v[36:37], v[66:67] op_sel:[1,0,0] op_sel_hi:[1,1,1] neg_lo:[1,0,0] neg_hi:[1,0,0]
    v_pk_fma_f32 v[38:39], v[96:97], v[20:21], v[68:69] op_sel:[1,0,0] op_sel_hi:[1,1,1]
    v_pk_fma_f32 v[66:67], v[96:97], v[22:23], v[24:25] op_sel:[0,0,0] op_sel_hi:[0,1,1]
    v_pk_fma_f32 v[68:69], v[96:97], v[38:39], v[40:41] op_sel:[0,0,0] op_sel_hi:[0,1,1]
    v_pk_fma_f32 v[24:25], v[96:97], v[38:39], v[66:67] op_sel:[1,0,0] op_sel_hi:[1,1,1] neg_lo:[1,0,0] neg_hi:[1,0,0]
    v_pk_fma_f32 v[40:41], v[96:97], v[22:23], v[68:69] op_sel:[1,0,0] op_sel_hi:[1,1,1]
    v_pk_fma_f32 v[66:67], v[96:97], v[24:25], v[26:27] op_sel:[0,0,0] op_sel_hi:[0,1,1]
    v_pk_fma_f32 v[68:69], v[96:97], v[40:41], v[42:43] op_sel:[0,0,0] op_sel_hi:[0,1,1]
    v_pk_fma_f32 v[26:27], v[96:97], v[40:41], v[66:67] op_sel:[1,0,0] op_sel_hi:[1,1,1] neg_lo:[1,0,0] neg_hi:[1,0,0]
    v_pk_fma_f32 v[42:43], v[96:97], v[24:25], v[68:69] op_sel:[1,0,0] op_sel_hi:[1,1,1]
    v_pk_fma_f32 v[66:67], v[96:97], v[26:27], v[28:29] op_sel:[0,0,0] op_sel_hi:[0,1,1]
    v_pk_fma_f32 v[68:69], v[96:97], v[42:43], v[44:45] op_sel:[0,0,0] op_sel_hi:[0,1,1]
    v_pk_fma_f32 v[28:29], v[96:97], v[42:43], v[66:67] op_sel:[1,0,0] op_sel_hi:[1,1,1] neg_lo:[1,0,0] neg_hi:[1,0,0]
    v_pk_fma_f32 v[44:45], v[96:97], v[26:27], v[68:69] op_sel:[1,0,0] op_sel_hi:[1,1,1]
    v_pk_fma_f32 v[66:67], v[96:97], v[28:29], v[30:31] op_sel:[0,0,0] op_sel_hi:[0,1,1]
    v_pk_fma_f32 v[68:69], v[96:97], v[44:45], v[46:47] op_sel:[0,0,0] op_sel_hi:[0,1,1]
    v_pk_fma_f32 v[30:31], v[96:97], v[44:45], v[66:67] op_sel:[1,0,0] op_sel_hi:[1,1,1] neg_lo:[1,0,0] neg_hi:[1,0,0]
    v_pk_fma_f32 v[46:47], v[96:97], v[28:29], v[68:69] op_sel:[1,0,0] op_sel_hi:[1,1,1]
    v_pk_mul_f32 v[66:67], v[98:99], v[32:33] op_sel:[1,0] op_sel_hi:[1,1]
    v_pk_mul_f32 v[68:69], v[98:99], v[16:17] op_sel:[1,0] op_sel_hi:[1,1]
    v_pk_fma_f32 v[16:17], v[98:99], v[16:17], v[66:67] op_sel:[0,0,0] op_sel_hi:[0,1,1] neg_lo:[0,0,1] neg_hi:[0,0,1]
    v_pk_fma_f32 v[32:33], v[98:99], v[32:33], v[68:69] op_sel:[0,0,0] op_sel_hi:[0,1,1] neg_lo:[1,0,1] neg_hi:[1,0,1]
    v_pk_mul_f32 v[70:71], v[98:99], v[34:35] op_sel:[1,0] op_sel_hi:[1,1]
    v_pk_mul_f32 v[76:77], v[98:99], v[18:19] op_sel:[1,0] op_sel_hi:[1,1]
    v_pk_fma_f32 v[18:19], v[98:99], v[18:19], v[70:71] op_sel:[0,0,0] op_sel_hi:[0,1,1] neg_lo:[0,0,1] neg_hi:[0,0,1]
    v_pk_fma_f32 v[34:35], v[98:99], v[34:35], v[76:77] op_sel:[0,0,0] op_sel_hi:[0,1,1] neg_lo:[1,0,1] neg_hi:[1,0,1]
    v_pk_mul_f32 v[66:67], v[98:99], v[36:37] op_sel:[1,0] op_sel_hi:[1,1]
    v_pk_mul_f32 v[68:69], v[98:99], v[20:21] op_sel:[1,0] op_sel_hi:[1,1]
    v_pk_fma_f32 v[20:21], v[98:99], v[20:21], v[66:67] op_sel:[0,0,0] op_sel_hi:[0,1,1] neg_lo:[0,0,1] neg_hi:[0,0,1]
    v_pk_fma_f32 v[36:37], v[98:99], v[36:37], v[68:69] op_sel:[0,0,0] op_sel_hi:[0,1,1] neg_lo:[1,0,1] neg_hi:[1,0,1]
    v_pk_mul_f32 v[70:71], v[98:99], v[38:39] op_sel:[1,0] op_sel_hi:[1,1]
    v_pk_mul_f32 v[76:77], v[98:99], v[22:23] op_sel:[1,0] op_sel_hi:[1,1]
    v_pk_fma_f32 v[22:23], v[98:99], v[22:23], v[70:71] op_sel:[0,0,0] op_sel_hi:[0,1,1] neg_lo:[0,0,1] neg_hi:[0,0,1]
    v_pk_fma_f32 v[38:39], v[98:99], v[38:39], v[76:77] op_sel:[0,0,0] op_sel_hi:[0,1,1] neg_lo:[1,0,1] neg_hi:[1,0,1]
    v_pk_mul_f32 v[66:67], v[98:99], v[40:41] op_sel:[1,0] op_sel_hi:[1,1]
    v_pk_mul_f32 v[68:69], v[98:99], v[24:25] op_sel:[1,0] op_sel_hi:[1,1]
    v_pk_fma_f32 v[24:25], v[98:99], v[24:25], v[66:67] op_sel:[0,0,0] op_sel_hi:[0,1,1] neg_lo:[0,0,1] neg_hi:[0,0,1]
    v_pk_fma_f32 v[40:41], v[98:99], v[40:41], v[68:69] op_sel:[0,0,0] op_sel_hi:[0,1,1] neg_lo:[1,0,1] neg_hi:[1,0,1]
    v_pk_mul_f32 v[70:71], v[98:99], v[42:43] op_sel:[1,0] op_sel_hi:[1,1]
    v_pk_mul_f32 v[76:77], v[98:99], v[26:27] op_sel:[1,0] op_sel_hi:[1,1]
    v_pk_fma_f32 v[26:27], v[98:99], v[26:27], v[70:71] op_sel:[0,0,0] op_sel_hi:[0,1,1] neg_lo:[0,0,1] neg_hi:[0,0,1]
    v_pk_fma_f32 v[42:43], v[98:99], v[42:43], v[76:77] op_sel:[0,0,0] op_sel_hi:[0,1,1] neg_lo:[1,0,1] neg_hi:[1,0,1]
    v_pk_mul_f32 v[66:67], v[98:99], v[44:45] op_sel:[1,0] op_sel_hi:[1,1]
    v_pk_mul_f32 v[68:69], v[98:99], v[28:29] op_sel:[1,0] op_sel_hi:[1,1]
    v_pk_fma_f32 v[28:29], v[98:99], v[28:29], v[66:67] op_sel:[0,0,0] op_sel_hi:[0,1,1] neg_lo:[0,0,1] neg_hi:[0,0,1]
    v_pk_fma_f32 v[44:45], v[98:99], v[44:45], v[68:69] op_sel:[0,0,0] op_sel_hi:[0,1,1] neg_lo:[1,0,1] neg_hi:[1,0,1]
    v_pk_mul_f32 v[70:71], v[98:99], v[46:47] op_sel:[1,0] op_sel_hi:[1,1]
    v_pk_mul_f32 v[76:77], v[98:99], v[30:31] op_sel:[1,0] op_sel_hi:[1,1]
    v_pk_fma_f32 v[30:31], v[98:99], v[30:31], v[70:71] op_sel:[0,0,0] op_sel_hi:[0,1,1] neg_lo:[0,0,1] neg_hi:[0,0,1]
    v_pk_fma_f32 v[46:47], v[98:99], v[46:47], v[76:77] op_sel:[0,0,0] op_sel_hi:[0,1,1] neg_lo:[1,0,1] neg_hi:[1,0,1]
    v_cvt_pk_bf16_f32 v80, v16, v17
    v_cvt_pk_bf16_f32 v81, v18, v19
    ds_write_b64 v15, v[80:81] offset:0
    v_cvt_pk_bf16_f32 v82, v20, v21
    v_cvt_pk_bf16_f32 v83, v22, v23
    ds_write_b64 v15, v[82:83] offset:16
    v_cvt_pk_bf16_f32 v84, v24, v25
    v_cvt_pk_bf16_f32 v85, v26, v27
    ds_write_b64 v15, v[84:85] offset:32
    v_cvt_pk_bf16_f32 v86, v28, v29
    v_cvt_pk_bf16_f32 v87, v30, v31
    ds_write_b64 v15, v[86:87] offset:48
    v_cvt_pk_bf16_f32 v88, v32, v33
    v_cvt_pk_bf16_f32 v89, v34, v35
    ds_write_b64 v15, v[88:89] offset:2304
    v_cvt_pk_bf16_f32 v90, v36, v37
    v_cvt_pk_bf16_f32 v91, v38, v39
    ds_write_b64 v15, v[90:91] offset:2320
    v_cvt_pk_bf16_f32 v92, v40, v41
    v_cvt_pk_bf16_f32 v93, v42, v43
    ds_write_b64 v15, v[92:93] offset:2336
    v_cvt_pk_bf16_f32 v94, v44, v45
    v_cvt_pk_bf16_f32 v95, v46, v47
    ds_write_b64 v15, v[94:95] offset:2352
    s_waitcnt lgkmcnt(0)
    ds_read_b64_tr_b16 v[64:65], v13 offset:0
    ds_read_b64_tr_b16 v[66:67], v13 offset:288
    ds_read_b64_tr_b16 v[68:69], v13 offset:1152
    ds_read_b64_tr_b16 v[70:71], v13 offset:1440
    ds_read_b64_tr_b16 v[72:73], v13 offset:2304
    ds_read_b64_tr_b16 v[74:75], v13 offset:2592
    ds_read_b64_tr_b16 v[76:77], v13 offset:3456
    ds_read_b64_tr_b16 v[78:79], v13 offset:3744
    s_lshl_b32 s76, s6, 12
    s_add_u32 s76, s76, 114688
    s_add_u32 s76, s76, s80
    s_waitcnt lgkmcnt(6)
    buffer_store_dwordx4 v[64:67], v14, s[56:59], s76 offen offset:0 sc1
    s_waitcnt lgkmcnt(4)
    buffer_store_dwordx4 v[68:71], v14, s[56:59], s76 offen offset:1024 sc1
    s_waitcnt lgkmcnt(2)
    buffer_store_dwordx4 v[72:75], v14, s[56:59], s76 offen offset:2048 sc1
    s_waitcnt lgkmcnt(0)
    buffer_store_dwordx4 v[76:79], v14, s[56:59], s76 offen offset:3072 sc1
    s_load_dwordx2 s[16:17], s[0:1], 0
    s_load_dwordx2 s[18:19], s[0:1], 64
    s_load_dwordx2 s[20:21], s[0:1], 104
    s_and_b32 s24, s2, 7
    s_lshr_b32 s25, s2, 3
    s_lshl_b32 s22, s24, 2
    s_lshr_b32 s26, s25, 3
    s_add_u32 s22, s22, s26
    s_and_b32 s23, s25, 7
    s_waitcnt lgkmcnt(0)
    s_lshl_b32 s26, s4, 6
    v_add_u32 v13, s26, v0
    v_lshrrev_b32 v15, 4, v13
    v_and_b32 v13, 15, v13
    v_bfe_u32 v9, v15, 2, 1
    v_lshlrev_b32 v9, 4, v9
    v_and_b32 v10, 1, v15
    v_lshl_add_u32 v9, v10, 3, v9
    v_lshrrev_b32 v10, 3, v15
    v_lshl_add_u32 v9, v10, 1, v9
    v_bfe_u32 v10, v15, 1, 1
    v_add_u32 v9, v9, v10
    s_lshl_b32 s26, s22, 6
    v_add_u32 v9, s26, v9
    s_lshl_b32 s27, s23, 7
    v_lshlrev_b32 v10, 10, v9
    v_lshl_add_u32 v10, v13, 3, v10
    v_add_u32 v10, s27, v10
    v_lshlrev_b32 v11, 2, v9
    v_lshlrev_b32 v12, 3, v13
    v_add_u32 v12, s27, v12
    s_lshl_b32 s27, s27, 1
    v_lshlrev_b32 v9, 11, v9
    v_lshl_add_u32 v9, v13, 4, v9
    v_add_u32 v9, s27, v9
    s_mov_b32 s64, s16
    s_and_b32 s65, s17, 0xffff
    s_mov_b32 s66, 2097152
    s_mov_b32 s67, 0x20000
    s_mov_b32 s68, s18
    s_and_b32 s69, s19, 0xffff
    s_mov_b32 s70, 1024
    s_mov_b32 s71, 0x20000
    s_mov_b32 s72, s20
    s_and_b32 s73, s21, 0xffff
    s_mov_b32 s74, 4194304
    s_mov_b32 s75, 0x20000
    s_mov_b32 s26, 32768
    buffer_load_dwordx2 v[124:125], v10, s[64:67], s26 offen
    s_mov_b32 s26, 36864
    buffer_load_dwordx2 v[126:127], v10, s[64:67], s26 offen
    buffer_load_dwordx2 v[6:7], v12, s[68:71], 0 offen
    s_waitcnt vmcnt(3)
    s_barrier
    s_barrier
    s_waitcnt vmcnt(0)
    v_lshlrev_b32 v108, 16, v6
    v_and_b32 v109, 0xffff0000, v6
    v_lshlrev_b32 v110, 16, v7
    v_and_b32 v111, 0xffff0000, v7
    v_lshlrev_b32 v13, 16, v124
    v_and_b32 v15, 0xffff0000, v124
    v_lshlrev_b32 v5, 16, v125
    v_and_b32 v8, 0xffff0000, v125
    v_mul_f32 v13, v13, v108
    v_mul_f32 v15, v15, v109
    v_mul_f32 v5, v5, v110
    v_mul_f32 v8, v8, v111
    v_cvt_pk_bf16_f32 v13, v13, v15
    v_cvt_pk_bf16_f32 v5, v5, v8
    v_lshlrev_b32 v120, 16, v13
    v_and_b32 v121, 0xffff0000, v13
    v_lshlrev_b32 v122, 16, v5
    v_and_b32 v123, 0xffff0000, v5
    v_lshlrev_b32 v13, 16, v126
    v_and_b32 v15, 0xffff0000, v126
    v_lshlrev_b32 v5, 16, v127
    v_and_b32 v8, 0xffff0000, v127
    v_mul_f32 v13, v13, v108
    v_mul_f32 v15, v15, v109
    v_mul_f32 v5, v5, v110
    v_mul_f32 v8, v8, v111
    v_cvt_pk_bf16_f32 v13, v13, v15
    v_cvt_pk_bf16_f32 v5, v5, v8
    v_lshlrev_b32 v124, 16, v13
    v_and_b32 v125, 0xffff0000, v13
    v_lshlrev_b32 v126, 16, v5
    v_and_b32 v127, 0xffff0000, v5
    s_barrier
    s_mov_b32 s26, 14417920
    buffer_load_dword v3, v11, s[56:59], s26 offen offset:128 sc1
    buffer_load_dword v4, v11, s[56:59], s26 offen offset:144 sc1
    s_waitcnt vmcnt(0)
    v_sub_f32 v7, 1.0, v3
    v_cvt_pk_bf16_f32 v7, v7, v7
    v_and_b32 v7, 0xffff0000, v7
    v_mul_f32 v120, v3, v120
    v_mul_f32 v121, v3, v121
    v_mul_f32 v122, v3, v122
    v_mul_f32 v123, v3, v123
    v_add_f32 v3, v3, v3
    v_sub_f32 v8, 1.0, v4
    v_cvt_pk_bf16_f32 v8, v8, v8
    v_and_b32 v8, 0xffff0000, v8
    v_mul_f32 v124, v4, v124
    v_mul_f32 v125, v4, v125
    v_mul_f32 v126, v4, v126
    v_mul_f32 v127, v4, v127
    v_add_f32 v4, v4, v4
    s_lshl_b32 s26, s4, 6
    v_add_u32 v10, s26, v0
    v_lshrrev_b32 v11, 4, v10
    v_and_b32 v10, 15, v10
    v_mul_u32_u24 v11, 272, v11
    v_lshl_add_u32 v11, v10, 4, v11
    v_add_u32 v10, 34816, v11
    s_barrier
    ds_read_b128 v[16:19], v11 offset:8704
    ds_read_b128 v[20:23], v11 offset:26112
    ds_read_b128 v[24:27], v10 offset:8704
    ds_read_b128 v[28:31], v10 offset:26112
    ds_read_b128 v[32:35], v10 offset:43520
    ds_read_b128 v[36:39], v11 offset:13056
    ds_read_b128 v[40:43], v11 offset:30464
    ds_read_b128 v[44:47], v10 offset:13056
    ds_read_b128 v[48:51], v10 offset:30464
    ds_read_b128 v[52:55], v10 offset:47872
    s_waitcnt lgkmcnt(5)
    v_pk_add_f32 v[16:17], v[16:17], v[20:21]
    v_pk_add_f32 v[28:29], v[28:29], v[32:33]
    v_pk_add_f32 v[18:19], v[18:19], v[22:23]
    v_pk_add_f32 v[30:31], v[30:31], v[34:35]
    v_pk_add_f32 v[16:17], v[16:17], v[24:25]
    v_pk_fma_f32 v[28:29], v[2:3], v[28:29], v[120:121] op_sel:[1,0,0] op_sel_hi:[1,1,1]
    v_pk_add_f32 v[18:19], v[18:19], v[26:27]
    v_pk_fma_f32 v[30:31], v[2:3], v[30:31], v[122:123] op_sel:[1,0,0] op_sel_hi:[1,1,1]
    v_cvt_pk_bf16_f32 v13, v16, v17
    v_cvt_pk_bf16_f32 v15, v18, v19
    v_lshlrev_b32 v16, 16, v13
    v_and_b32 v17, 0xffff0000, v13
    v_lshlrev_b32 v18, 16, v15
    v_and_b32 v19, 0xffff0000, v15
    v_pk_mul_f32 v[16:17], v[6:7], v[16:17] op_sel:[1,0] op_sel_hi:[1,1]
    v_pk_mul_f32 v[18:19], v[6:7], v[18:19] op_sel:[1,0] op_sel_hi:[1,1]
    v_cvt_pk_bf16_f32 v13, v16, v17
    v_cvt_pk_bf16_f32 v15, v18, v19
    v_lshlrev_b32 v16, 16, v13
    v_and_b32 v17, 0xffff0000, v13
    v_lshlrev_b32 v18, 16, v15
    v_and_b32 v19, 0xffff0000, v15
    v_pk_add_f32 v[16:17], v[16:17], v[28:29]
    v_pk_add_f32 v[18:19], v[18:19], v[30:31]
    s_mov_b32 s26, 65536
    buffer_store_dwordx4 v[16:19], v9, s[72:75], s26 offen sc1
    s_waitcnt lgkmcnt(0)
    v_pk_add_f32 v[36:37], v[36:37], v[40:41]
    v_pk_add_f32 v[48:49], v[48:49], v[52:53]
    v_pk_add_f32 v[38:39], v[38:39], v[42:43]
    v_pk_add_f32 v[50:51], v[50:51], v[54:55]
    v_pk_add_f32 v[36:37], v[36:37], v[44:45]
    v_pk_fma_f32 v[48:49], v[4:5], v[48:49], v[124:125] op_sel:[0,0,0] op_sel_hi:[0,1,1]
    v_pk_add_f32 v[38:39], v[38:39], v[46:47]
    v_pk_fma_f32 v[50:51], v[4:5], v[50:51], v[126:127] op_sel:[0,0,0] op_sel_hi:[0,1,1]
    v_cvt_pk_bf16_f32 v13, v36, v37
    v_cvt_pk_bf16_f32 v15, v38, v39
    v_lshlrev_b32 v36, 16, v13
    v_and_b32 v37, 0xffff0000, v13
    v_lshlrev_b32 v38, 16, v15
    v_and_b32 v39, 0xffff0000, v15
    v_pk_mul_f32 v[36:37], v[8:9], v[36:37] op_sel:[0,0] op_sel_hi:[0,1]
    v_pk_mul_f32 v[38:39], v[8:9], v[38:39] op_sel:[0,0] op_sel_hi:[0,1]
    v_cvt_pk_bf16_f32 v13, v36, v37
    v_cvt_pk_bf16_f32 v15, v38, v39
    v_lshlrev_b32 v36, 16, v13
    v_and_b32 v37, 0xffff0000, v13
    v_lshlrev_b32 v38, 16, v15
    v_and_b32 v39, 0xffff0000, v15
    v_pk_add_f32 v[36:37], v[36:37], v[48:49]
    v_pk_add_f32 v[38:39], v[38:39], v[50:51]
    s_mov_b32 s26, 73728
    buffer_store_dwordx4 v[36:39], v9, s[72:75], s26 offen sc1
    s_endpgm
K1_END:
    s_endpgm
.section .rodata,"a"
.p2align 6
.amdhsa_kernel gated_mix__ssm_conv_s5__dense_activation_silu__prompt_kernel
  .amdhsa_next_free_vgpr 256
  .amdhsa_next_free_sgpr 102
  .amdhsa_accum_offset 128
  .amdhsa_group_segment_fixed_size 0
  .amdhsa_kernarg_size 128
  .amdhsa_user_sgpr_count 2
  .amdhsa_user_sgpr_kernarg_segment_ptr 1
  .amdhsa_system_sgpr_workgroup_id_x 1
  .amdhsa_float_denorm_mode_32 3
  .amdhsa_float_denorm_mode_16_64 3
.end_amdhsa_kernel
```
